```python
import torch

def _softmax(x, axis=-1):
    return torch.softmax(x, dim=axis)

def _gelu(x):
    return torch.nn.functional.gelu(x, approximate='tanh')

def _silu(x):
    return torch.nn.functional.silu(x)

def _sigmoid(x):
    return torch.sigmoid(x)

def _layernorm(x, axis=-1, eps=1e-05):
    m = x.mean(dim=axis, keepdim=True)
    v = x.var(dim=axis, keepdim=True, unbiased=False)
    return (x - m) / torch.sqrt(v + eps)

def _scatter_add(tgt, idx, src, axis=0):
    return tgt.clone().index_add_(axis, idx, src)

def _segment_sum(src, seg, n):
    out = torch.zeros((n,) + src.shape[1:], dtype=src.dtype)
    return out.index_add_(0, seg, src)

def _pad(x, pw):
    flat = tuple((v for pair in reversed(pw) for v in pair))
    return torch.nn.functional.pad(x, flat)
kernel_name = 'standalone__molecular_angular_painn__graph'

def setup_inputs():

    _w = lambda a: (lambda t: t.to(torch.bfloat16) if t.is_floating_point() else t)(torch.as_tensor(a))
    N, deg, D = (10000, 16, 256)
    n_rbf = max(16, 4)
    E = N * deg
    cutoff = 5.0
    freqs = (torch.arange(1, n_rbf + 1) * torch.pi / cutoff).to(float)
    return {'sv': _w((lambda *s: torch.randn(*s, dtype=torch.bfloat16) * 0.4)(N, 4, D) * 0.3), 'pos': _w((lambda *s: torch.randn(*s, dtype=torch.bfloat16) * 1.6)(N, 3) * 1.2), 'src': _w((lambda lo, hi, *s: torch.randint(lo, hi, s))(0, N, E).to(torch.int64)), 'dst': _w((lambda lo, hi, *s: torch.randint(lo, hi, s))(0, N, E).to(torch.int64)), 'freqs': _w(freqs), 'w_phi1': _w((lambda *s: torch.randn(*s, dtype=torch.bfloat16) * 3.2)(D, D) / D ** 0.5), 'w_phi2': _w((lambda *s: torch.randn(*s, dtype=torch.bfloat16) * 1.6)(D, 3 * D) / D ** 0.5), 'w_rbf': _w((lambda *s: torch.randn(*s, dtype=torch.bfloat16) * 1.6)(n_rbf, 3 * D) / n_rbf ** 0.5)}

def reference(sv, pos, src, dst, freqs, w_phi1, w_phi2, w_rbf):
    N, _, D = sv.shape
    E = src.shape[0]
    PI, cutoff = (3.141592653589793, 5.0)
    s, v = (sv[:, 0, :].clone(), sv[:, 1:, :].clone())
    r_vec = pos[src] - pos[dst]
    d = torch.sqrt((r_vec * r_vec).sum(-1) + 1e-08)
    r_hat = r_vec / d[:, None]
    rbf = torch.sin(d[:, None] * freqs[None, :]) / d[:, None]
    fcut = 0.5 * (torch.cos(PI * d / cutoff) + 1.0)
    fcut = torch.where(d < cutoff, fcut, 0.0 * d)
    Wf = rbf @ w_rbf * fcut[:, None]
    phi = (_silu(s @ w_phi1) @ w_phi2)[src]
    m = phi * Wf
    m_s, m_vv, m_vr = (m[:, :D].clone(), m[:, D:2 * D].clone(), m[:, 2 * D:].clone())
    ds = _segment_sum(m_s, dst, N)
    dv_e = m_vv[:, None, :] * v[src] + m_vr[:, None, :] * r_hat[:, :, None]
    dv = _segment_sum(dv_e.reshape(E, 3 * D), dst, N).reshape(N, 3, D)
    return sv + torch.concatenate([ds[:, None, :], dv], axis=1)
```

```asm
; @launch kernel=standalone__molecular_angular_painn__graph_kernel grid=(256,1,1) block=(512,1,1) lds=163840
.amdgcn_target "amdgcn-amd-amdhsa--gfx950"
.text
.globl standalone__molecular_angular_painn__graph_kernel
.p2align 8
.type standalone__molecular_angular_painn__graph_kernel,@function
standalone__molecular_angular_painn__graph_kernel:
    s_cmp_ge_u32 s2, 256
    s_cbranch_scc1 K1_END_6
    s_load_dwordx16 s[4:19], s[0:1], 0
    s_load_dwordx4 s[20:23], s[0:1], 64
    s_load_dwordx2 s[24:25], s[0:1], 80
    v_lshrrev_b32 v1, 6, v0
    s_nop 0
    v_readfirstlane_b32 s3, v1
    s_lshr_b32 s26, s2, 3
    s_cmp_lg_u32 s26, 5
    s_cbranch_scc1 K1_NOCPF_9
    s_getpc_b64 s[28:29]
PC_5:
    s_mov_b32 s30, CODE_END_4-PC_5
    s_mov_b32 s31, 0x20000
    v_lshlrev_b32 v1, 7, v0
    buffer_load_dword v255, v1, s[28:31], 0 offen
K1_NOCPF_9:
    s_cmp_lt_u32 s2, 46
    s_cbranch_scc1 K1_SIDE_2
K1_GEMM_7:
    s_sub_u32 s48, s2, 46
    s_lshr_b32 s62, s48, 3
    s_and_b32 s26, s62, 1
    s_lshr_b32 s62, s62, 1
    s_lshl_b32 s57, s62, 3
    s_and_b32 s49, s48, 7
    s_and_b32 s50, s48, 1
    s_cmp_ge_u32 s48, 208
    s_cselect_b32 s49, 0, s49
    s_cselect_b32 s26, s50, s26
    s_add_u32 s57, s57, s49
    s_and_b32 s62, s62, 7
    s_mul_i32 s57, s57, 96
    s_lshl_b32 s59, s57, 11
    s_and_b32 s61, s3, 3
    s_and_b32 s48, s61, 1
    s_lshr_b32 s49, s61, 1
    s_lshl_b32 s50, s49, 2
    s_add_u32 s50, s50, s48
    s_lshl_b32 s58, s50, 10
    v_bfe_u32 v19, v0, 5, 1
    v_and_b32 v20, 31, v0
    s_lshl_b32 s51, s61, 2
    v_lshl_add_u32 v21, v19, 1, s51
    v_xor_b32 v21, v21, v20
    v_lshlrev_b32 v21, 4, v21
    v_lshl_add_u32 v1, v19, 9, v21
    v_add_u32 v1, s58, v1
    s_lshl_b32 s52, s61, 12
    v_lshl_add_u32 v22, v19, 11, v21
    v_add_u32 v22, s52, v22
    s_lshl_b32 s63, s61, 10
    s_xor_b32 s64, s62, 0
    s_lshl_b32 s64, s64, 14
    s_xor_b32 s65, s62, 1
    s_lshl_b32 s65, s65, 14
    s_xor_b32 s66, s62, 2
    s_lshl_b32 s66, s66, 14
    s_xor_b32 s67, s62, 3
    s_lshl_b32 s67, s67, 14
    s_xor_b32 s68, s62, 4
    s_lshl_b32 s68, s68, 14
    s_xor_b32 s69, s62, 5
    s_lshl_b32 s69, s69, 14
    s_xor_b32 s70, s62, 6
    s_lshl_b32 s70, s70, 14
    s_xor_b32 s71, s62, 7
    s_lshl_b32 s71, s71, 14
    s_waitcnt lgkmcnt(0)
    s_mov_b32 s28, s4
    s_mov_b32 s29, s5
    s_mov_b32 s30, 20480000
    s_mov_b32 s31, 0x20000
    s_mov_b32 s32, s14
    s_mov_b32 s33, s15
    s_mov_b32 s34, 131072
    s_mov_b32 s35, 0x20000
    s_cmp_ge_u32 s3, 4
    s_cbranch_scc1 K1_G0_24
    s_add_u32 m0, s63, 106496
    s_add_u32 s48, s59, 0
    buffer_load_dwordx4 v22, s[28:31], s48 offen lds
    s_add_u32 m0, s63, 110592
    s_add_u32 s48, s59, 16384
    buffer_load_dwordx4 v22, s[28:31], s48 offen lds
    s_add_u32 m0, s63, 114688
    s_add_u32 s48, s59, 32768
    buffer_load_dwordx4 v22, s[28:31], s48 offen lds
    s_add_u32 m0, s63, 118784
    s_add_u32 s48, s59, 49152
    buffer_load_dwordx4 v22, s[28:31], s48 offen lds
    s_add_u32 m0, s63, 122880
    s_add_u32 s48, s59, 65536
    buffer_load_dwordx4 v22, s[28:31], s48 offen lds
    s_add_u32 m0, s63, 126976
    s_add_u32 s48, s59, 81920
    buffer_load_dwordx4 v22, s[28:31], s48 offen lds
    s_add_u32 m0, s63, 131072
    s_add_u32 s48, s59, 98304
    buffer_load_dwordx4 v22, s[28:31], s48 offen lds
    s_add_u32 m0, s63, 135168
    s_add_u32 s48, s59, 114688
    buffer_load_dwordx4 v22, s[28:31], s48 offen lds
    s_add_u32 m0, s63, 139264
    s_add_u32 s48, s59, 131072
    buffer_load_dwordx4 v22, s[28:31], s48 offen lds
    s_add_u32 m0, s63, 143360
    s_add_u32 s48, s59, 147456
    buffer_load_dwordx4 v22, s[28:31], s48 offen lds
    s_add_u32 m0, s63, 147456
    s_add_u32 s48, s59, 163840
    buffer_load_dwordx4 v22, s[28:31], s48 offen lds
    s_add_u32 m0, s63, 151552
    s_add_u32 s48, s59, 180224
    buffer_load_dwordx4 v22, s[28:31], s48 offen lds
    s_add_u32 m0, s58, 73728
    s_add_u32 s48, s64, 0
    buffer_load_dwordx4 v1, s[32:35], s48 offen lds
    s_add_u32 m0, s58, 75776
    s_add_u32 s48, s64, 2048
    buffer_load_dwordx4 v1, s[32:35], s48 offen lds
    s_add_u32 m0, s58, 81920
    s_add_u32 s48, s64, 8192
    buffer_load_dwordx4 v1, s[32:35], s48 offen lds
    s_add_u32 m0, s58, 83968
    s_add_u32 s48, s64, 10240
    buffer_load_dwordx4 v1, s[32:35], s48 offen lds
    s_add_u32 m0, s58, 90112
    s_add_u32 s48, s65, 0
    buffer_load_dwordx4 v1, s[32:35], s48 offen lds
    s_add_u32 m0, s58, 92160
    s_add_u32 s48, s65, 2048
    buffer_load_dwordx4 v1, s[32:35], s48 offen lds
    s_add_u32 m0, s58, 98304
    s_add_u32 s48, s65, 8192
    buffer_load_dwordx4 v1, s[32:35], s48 offen lds
    s_add_u32 m0, s58, 100352
    s_add_u32 s48, s65, 10240
    buffer_load_dwordx4 v1, s[32:35], s48 offen lds
    s_add_u32 m0, s58, 0
    s_add_u32 s48, s66, 0
    buffer_load_dwordx4 v1, s[32:35], s48 offen lds
    s_add_u32 m0, s58, 2048
    s_add_u32 s48, s66, 2048
    buffer_load_dwordx4 v1, s[32:35], s48 offen lds
    s_add_u32 m0, s58, 8192
    s_add_u32 s48, s66, 8192
    buffer_load_dwordx4 v1, s[32:35], s48 offen lds
    s_add_u32 m0, s58, 10240
    s_add_u32 s48, s66, 10240
    buffer_load_dwordx4 v1, s[32:35], s48 offen lds
    s_add_u32 m0, s58, 16384
    s_add_u32 s48, s67, 0
    buffer_load_dwordx4 v1, s[32:35], s48 offen lds
    s_add_u32 m0, s58, 18432
    s_add_u32 s48, s67, 2048
    buffer_load_dwordx4 v1, s[32:35], s48 offen lds
    s_add_u32 m0, s58, 24576
    s_add_u32 s48, s67, 8192
    buffer_load_dwordx4 v1, s[32:35], s48 offen lds
    s_add_u32 m0, s58, 26624
    s_add_u32 s48, s67, 10240
    buffer_load_dwordx4 v1, s[32:35], s48 offen lds
K1_G0_24:
    s_mul_i32 s72, s64, 3
    s_mul_i32 s73, s65, 3
    s_mul_i32 s74, s66, 3
    s_mul_i32 s75, s67, 3
    s_mul_i32 s76, s68, 3
    s_mul_i32 s77, s69, 3
    s_mul_i32 s78, s70, 3
    s_mul_i32 s79, s71, 3
    s_mov_b32 s36, s16
    s_mov_b32 s37, s17
    s_mov_b32 s38, 393216
    s_mov_b32 s39, 0x20000
    s_lshl_b32 s52, s26, 1
    s_add_u32 s52, s52, s49
    s_mul_i32 s52, s52, 6400000
    s_add_u32 s40, s24, s52
    s_addc_u32 s41, s25, 0
    s_mov_b32 s42, 6400000
    s_mov_b32 s43, 0x20000
    s_lshl_b32 s52, s26, 8
    v_lshl_add_u32 v23, v19, 4, s50
    v_mul_u32_u24 v23, 1536, v23
    v_and_b32 v24, 0xf0, v21
    v_add3_u32 v23, v23, v24, s52
    v_lshrrev_b32 v24, 4, v20
    v_xor_b32 v25, 1, v24
    v_lshl_add_u32 v2, v25, 9, v23
    v_xor_b32 v24, s62, v24
    v_and_b32 v24, 1, v24
    v_mul_u32_u24 v24, 49152, v24
    v_add_u32 v3, v23, v24
    s_mov_b32 s56, 0x07060302
    s_mov_b32 s60, 0x8000
    s_mov_b32 s80, 0x55555555
    s_mov_b32 s81, 0x55555555
    v_bfe_u32 v17, v0, 4, 4
    v_and_b32 v18, 15, v0
    v_lshlrev_b32 v4, 11, v17
    v_lshl_add_u32 v4, v18, 4, v4
    v_add_u32 v4, s52, v4
    v_bfe_u32 v17, v0, 4, 2
    v_and_b32 v19, 7, v18
    v_lshlrev_b32 v19, 1, v19
    v_xor_b32 v19, v19, v17
    v_lshlrev_b32 v19, 4, v19
    v_lshl_add_u32 v5, v18, 9, v19
    s_lshl_b32 s52, s62, 6
    v_xor_b32 v5, s52, v5
    v_add_u32 v5, 106496, v5
    v_lshrrev_b32 v19, 2, v18
    v_and_b32 v20, 1, v17
    v_lshl_or_b32 v20, v20, 2, v19
    v_lshlrev_b32 v20, 1, v20
    v_bfe_u32 v21, v0, 1, 1
    v_or_b32 v21, s51, v21
    v_xor_b32 v20, v20, v21
    v_lshl_add_u32 v19, v17, 3, v19
    v_lshlrev_b32 v19, 9, v19
    v_lshl_add_u32 v19, v20, 4, v19
    v_and_b32 v20, 1, v0
    v_lshl_add_u32 v7, v20, 3, v19
    v_xor_b32 v8, 32, v7
    v_add_u32 v9, 73728, v7
    v_add_u32 v10, 73728, v8
    v_lshrrev_b32 v19, 2, v18
    v_or_b32 v19, s51, v19
    v_and_b32 v20, 1, v17
    v_lshlrev_b32 v20, 3, v20
    v_xor_b32 v19, v19, v20
    v_lshlrev_b32 v19, 4, v19
    v_and_b32 v20, 3, v18
    v_lshl_add_u32 v19, v20, 2, v19
    v_lshl_add_u32 v19, v17, 11, v19
    v_add_u32 v12, 106496, v19
    v_xor_b32 v13, 32, v12
    v_xor_b32 v14, 64, v12
    v_xor_b32 v15, 96, v12
    s_cmp_ge_u32 s3, 4
    s_cbranch_scc1 K1_G1_25
    s_waitcnt lgkmcnt(0)
    s_waitcnt vmcnt(8)
    s_barrier
    s_add_u32 m0, s58, 32768
    s_add_u32 s48, s68, 0
    buffer_load_dwordx4 v1, s[32:35], s48 offen lds
    s_add_u32 m0, s58, 34816
    s_add_u32 s48, s68, 2048
    buffer_load_dwordx4 v1, s[32:35], s48 offen lds
    s_add_u32 m0, s58, 40960
    s_add_u32 s48, s68, 8192
    buffer_load_dwordx4 v1, s[32:35], s48 offen lds
    s_add_u32 m0, s58, 43008
    s_add_u32 s48, s68, 10240
    buffer_load_dwordx4 v1, s[32:35], s48 offen lds
    s_add_u32 m0, s58, 49152
    s_add_u32 s48, s69, 0
    buffer_load_dwordx4 v1, s[32:35], s48 offen lds
    s_add_u32 m0, s58, 51200
    s_add_u32 s48, s69, 2048
    buffer_load_dwordx4 v1, s[32:35], s48 offen lds
    s_add_u32 m0, s58, 57344
    s_add_u32 s48, s69, 8192
    buffer_load_dwordx4 v1, s[32:35], s48 offen lds
    s_add_u32 m0, s58, 59392
    s_add_u32 s48, s69, 10240
    buffer_load_dwordx4 v1, s[32:35], s48 offen lds
    s_waitcnt lgkmcnt(0)
    s_waitcnt vmcnt(8)
    s_barrier
    s_add_u32 m0, s58, 73728
    s_add_u32 s48, s70, 0
    buffer_load_dwordx4 v1, s[32:35], s48 offen lds
    s_add_u32 m0, s58, 75776
    s_add_u32 s48, s70, 2048
    buffer_load_dwordx4 v1, s[32:35], s48 offen lds
    s_add_u32 m0, s58, 81920
    s_add_u32 s48, s70, 8192
    buffer_load_dwordx4 v1, s[32:35], s48 offen lds
    s_add_u32 m0, s58, 83968
    s_add_u32 s48, s70, 10240
    buffer_load_dwordx4 v1, s[32:35], s48 offen lds
    s_add_u32 m0, s58, 90112
    s_add_u32 s48, s71, 0
    buffer_load_dwordx4 v1, s[32:35], s48 offen lds
    s_add_u32 m0, s58, 92160
    s_add_u32 s48, s71, 2048
    buffer_load_dwordx4 v1, s[32:35], s48 offen lds
    s_add_u32 m0, s58, 98304
    s_add_u32 s48, s71, 8192
    buffer_load_dwordx4 v1, s[32:35], s48 offen lds
    s_add_u32 m0, s58, 100352
    s_add_u32 s48, s71, 10240
    buffer_load_dwordx4 v1, s[32:35], s48 offen lds
    s_waitcnt lgkmcnt(0)
    s_waitcnt vmcnt(8)
    s_barrier
    s_add_u32 m0, s58, 0
    s_add_u32 s48, s72, 0
    buffer_load_dwordx4 v2, s[36:39], s48 offen lds
    s_add_u32 m0, s58, 2048
    s_add_u32 s48, s72, 3072
    buffer_load_dwordx4 v2, s[36:39], s48 offen lds
    s_add_u32 m0, s58, 8192
    s_add_u32 s48, s72, 12288
    buffer_load_dwordx4 v2, s[36:39], s48 offen lds
    s_add_u32 m0, s58, 10240
    s_add_u32 s48, s72, 15360
    buffer_load_dwordx4 v2, s[36:39], s48 offen lds
    s_add_u32 m0, s58, 16384
    s_add_u32 s48, s73, 0
    buffer_load_dwordx4 v2, s[36:39], s48 offen lds
    s_add_u32 m0, s58, 18432
    s_add_u32 s48, s73, 3072
    buffer_load_dwordx4 v2, s[36:39], s48 offen lds
    s_add_u32 m0, s58, 24576
    s_add_u32 s48, s73, 12288
    buffer_load_dwordx4 v2, s[36:39], s48 offen lds
    s_add_u32 m0, s58, 26624
    s_add_u32 s48, s73, 15360
    buffer_load_dwordx4 v2, s[36:39], s48 offen lds
    s_waitcnt lgkmcnt(0)
    s_waitcnt vmcnt(8)
    s_barrier
    s_add_u32 m0, s58, 32768
    s_add_u32 s48, s74, 0
    buffer_load_dwordx4 v2, s[36:39], s48 offen lds
    s_add_u32 m0, s58, 34816
    s_add_u32 s48, s74, 3072
    buffer_load_dwordx4 v2, s[36:39], s48 offen lds
    s_add_u32 m0, s58, 40960
    s_add_u32 s48, s74, 12288
    buffer_load_dwordx4 v2, s[36:39], s48 offen lds
    s_add_u32 m0, s58, 43008
    s_add_u32 s48, s74, 15360
    buffer_load_dwordx4 v2, s[36:39], s48 offen lds
    s_add_u32 m0, s58, 49152
    s_add_u32 s48, s75, 0
    buffer_load_dwordx4 v2, s[36:39], s48 offen lds
    s_add_u32 m0, s58, 51200
    s_add_u32 s48, s75, 3072
    buffer_load_dwordx4 v2, s[36:39], s48 offen lds
    s_add_u32 m0, s58, 57344
    s_add_u32 s48, s75, 12288
    buffer_load_dwordx4 v2, s[36:39], s48 offen lds
    s_add_u32 m0, s58, 59392
    s_add_u32 s48, s75, 15360
    buffer_load_dwordx4 v2, s[36:39], s48 offen lds
    s_waitcnt lgkmcnt(0)
    s_waitcnt vmcnt(8)
    s_barrier
    s_add_u32 m0, s58, 73728
    s_add_u32 s48, s76, 0
    buffer_load_dwordx4 v2, s[36:39], s48 offen lds
    s_add_u32 m0, s58, 75776
    s_add_u32 s48, s76, 3072
    buffer_load_dwordx4 v2, s[36:39], s48 offen lds
    s_add_u32 m0, s58, 81920
    s_add_u32 s48, s76, 12288
    buffer_load_dwordx4 v2, s[36:39], s48 offen lds
    s_add_u32 m0, s58, 83968
    s_add_u32 s48, s76, 15360
    buffer_load_dwordx4 v2, s[36:39], s48 offen lds
    s_add_u32 m0, s58, 90112
    s_add_u32 s48, s77, 0
    buffer_load_dwordx4 v2, s[36:39], s48 offen lds
    s_add_u32 m0, s58, 92160
    s_add_u32 s48, s77, 3072
    buffer_load_dwordx4 v2, s[36:39], s48 offen lds
    s_add_u32 m0, s58, 98304
    s_add_u32 s48, s77, 12288
    buffer_load_dwordx4 v2, s[36:39], s48 offen lds
    s_add_u32 m0, s58, 100352
    s_add_u32 s48, s77, 15360
    buffer_load_dwordx4 v2, s[36:39], s48 offen lds
    ds_read_b64_tr_b16 v[32:33], v7 offset:0
    ds_read_b64_tr_b16 v[34:35], v7 offset:2048
    ds_read_b64_tr_b16 v[36:37], v8 offset:0
    ds_read_b64_tr_b16 v[38:39], v8 offset:2048
    ds_read_b64_tr_b16 v[40:41], v7 offset:256
    ds_read_b64_tr_b16 v[42:43], v7 offset:2304
    ds_read_b64_tr_b16 v[44:45], v8 offset:256
    ds_read_b64_tr_b16 v[46:47], v8 offset:2304
    ds_read_b64_tr_b16 v[48:49], v7 offset:16384
    ds_read_b64_tr_b16 v[50:51], v7 offset:18432
    ds_read_b64_tr_b16 v[52:53], v8 offset:16384
    ds_read_b64_tr_b16 v[54:55], v8 offset:18432
    s_waitcnt lgkmcnt(6)
    ds_read_b64_tr_b16 v[56:57], v7 offset:16640
    ds_read_b64_tr_b16 v[58:59], v7 offset:18688
    ds_read_b64_tr_b16 v[60:61], v8 offset:16640
    ds_read_b64_tr_b16 v[62:63], v8 offset:18688
    s_waitcnt lgkmcnt(0)
    s_waitcnt vmcnt(8)
    s_barrier
    s_add_u32 m0, s58, 0
    s_add_u32 s48, s78, 0
    buffer_load_dwordx4 v2, s[36:39], s48 offen lds
    s_add_u32 m0, s58, 2048
    s_add_u32 s48, s78, 3072
    buffer_load_dwordx4 v2, s[36:39], s48 offen lds
    s_add_u32 m0, s58, 8192
    s_add_u32 s48, s78, 12288
    buffer_load_dwordx4 v2, s[36:39], s48 offen lds
    s_add_u32 m0, s58, 10240
    s_add_u32 s48, s78, 15360
    buffer_load_dwordx4 v2, s[36:39], s48 offen lds
    s_add_u32 m0, s58, 16384
    s_add_u32 s48, s79, 0
    buffer_load_dwordx4 v2, s[36:39], s48 offen lds
    s_add_u32 m0, s58, 18432
    s_add_u32 s48, s79, 3072
    buffer_load_dwordx4 v2, s[36:39], s48 offen lds
    s_add_u32 m0, s58, 24576
    s_add_u32 s48, s79, 12288
    buffer_load_dwordx4 v2, s[36:39], s48 offen lds
    s_add_u32 m0, s58, 26624
    s_add_u32 s48, s79, 15360
    buffer_load_dwordx4 v2, s[36:39], s48 offen lds
    ds_read_b64_tr_b16 v[64:65], v7 offset:32768
    ds_read_b64_tr_b16 v[66:67], v7 offset:34816
    ds_read_b64_tr_b16 v[68:69], v8 offset:32768
    ds_read_b64_tr_b16 v[70:71], v8 offset:34816
    ds_read_b64_tr_b16 v[72:73], v7 offset:33024
    ds_read_b64_tr_b16 v[74:75], v7 offset:35072
    ds_read_b64_tr_b16 v[76:77], v8 offset:33024
    ds_read_b64_tr_b16 v[78:79], v8 offset:35072
    ds_read_b64_tr_b16 v[80:81], v7 offset:49152
    ds_read_b64_tr_b16 v[82:83], v7 offset:51200
    ds_read_b64_tr_b16 v[84:85], v8 offset:49152
    ds_read_b64_tr_b16 v[86:87], v8 offset:51200
    s_waitcnt lgkmcnt(6)
    ds_read_b64_tr_b16 v[88:89], v7 offset:49408
    ds_read_b64_tr_b16 v[90:91], v7 offset:51456
    ds_read_b64_tr_b16 v[92:93], v8 offset:49408
    ds_read_b64_tr_b16 v[94:95], v8 offset:51456
    s_add_u32 m0, s63, 65536
    s_add_u32 s48, s59, 132608
    buffer_load_dwordx4 v4, s[28:31], s48 offen lds
    s_add_u32 m0, s63, 69632
    s_add_u32 s48, s59, 165376
    buffer_load_dwordx4 v4, s[28:31], s48 offen lds
    s_waitcnt lgkmcnt(0)
    s_waitcnt vmcnt(10)
    s_barrier
    ds_read_b64_tr_b16 v[96:97], v9 offset:0
    ds_read_b64_tr_b16 v[98:99], v9 offset:2048
    ds_read_b64_tr_b16 v[100:101], v10 offset:0
    ds_read_b64_tr_b16 v[102:103], v10 offset:2048
    ds_read_b64_tr_b16 v[104:105], v9 offset:256
    ds_read_b64_tr_b16 v[106:107], v9 offset:2304
    ds_read_b64_tr_b16 v[108:109], v10 offset:256
    ds_read_b64_tr_b16 v[110:111], v10 offset:2304
    ds_read_b64_tr_b16 v[112:113], v9 offset:16384
    ds_read_b64_tr_b16 v[114:115], v9 offset:18432
    ds_read_b64_tr_b16 v[116:117], v10 offset:16384
    ds_read_b64_tr_b16 v[118:119], v10 offset:18432
    s_waitcnt lgkmcnt(6)
    ds_read_b64_tr_b16 v[120:121], v9 offset:16640
    ds_read_b64_tr_b16 v[122:123], v9 offset:18688
    ds_read_b64_tr_b16 v[124:125], v10 offset:16640
    ds_read_b64_tr_b16 v[126:127], v10 offset:18688
    s_add_u32 m0, s63, 49152
    s_add_u32 s48, s59, 1536
    buffer_load_dwordx4 v4, s[28:31], s48 offen lds
    s_add_u32 m0, s63, 53248
    s_add_u32 s48, s59, 34304
    buffer_load_dwordx4 v4, s[28:31], s48 offen lds
    s_add_u32 m0, s63, 57344
    s_add_u32 s48, s59, 67072
    buffer_load_dwordx4 v4, s[28:31], s48 offen lds
    s_add_u32 m0, s63, 61440
    s_add_u32 s48, s59, 99840
    buffer_load_dwordx4 v4, s[28:31], s48 offen lds
    s_waitcnt lgkmcnt(0)
    s_waitcnt vmcnt(6)
    s_barrier
    ds_read_b64_tr_b16 v[128:129], v7 offset:0
    ds_read_b64_tr_b16 v[130:131], v7 offset:2048
    ds_read_b64_tr_b16 v[132:133], v8 offset:0
    ds_read_b64_tr_b16 v[134:135], v8 offset:2048
    ds_read_b64_tr_b16 v[136:137], v7 offset:256
    ds_read_b64_tr_b16 v[138:139], v7 offset:2304
    ds_read_b64_tr_b16 v[140:141], v8 offset:256
    ds_read_b64_tr_b16 v[142:143], v8 offset:2304
    ds_read_b64_tr_b16 v[144:145], v7 offset:16384
    ds_read_b64_tr_b16 v[146:147], v7 offset:18432
    ds_read_b64_tr_b16 v[148:149], v8 offset:16384
    ds_read_b64_tr_b16 v[150:151], v8 offset:18432
    s_waitcnt lgkmcnt(6)
    ds_read_b64_tr_b16 v[152:153], v7 offset:16640
    ds_read_b64_tr_b16 v[154:155], v7 offset:18688
    ds_read_b64_tr_b16 v[156:157], v8 offset:16640
    ds_read_b64_tr_b16 v[158:159], v8 offset:18688
    s_add_u32 m0, s63, 32768
    s_add_u32 s48, s59, 66560
    buffer_load_dwordx4 v4, s[28:31], s48 offen lds
    s_add_u32 m0, s63, 36864
    s_add_u32 s48, s59, 99328
    buffer_load_dwordx4 v4, s[28:31], s48 offen lds
    s_waitcnt lgkmcnt(0)
    s_barrier
    s_add_u32 m0, s63, 40960
    s_add_u32 s48, s59, 132096
    buffer_load_dwordx4 v4, s[28:31], s48 offen lds
    s_add_u32 m0, s63, 45056
    s_add_u32 s48, s59, 164864
    buffer_load_dwordx4 v4, s[28:31], s48 offen lds
    s_add_u32 m0, s63, 0
    s_add_u32 s48, s59, 512
    buffer_load_dwordx4 v4, s[28:31], s48 offen lds
    s_waitcnt lgkmcnt(0)
    s_barrier
    s_add_u32 m0, s63, 4096
    s_add_u32 s48, s59, 33280
    buffer_load_dwordx4 v4, s[28:31], s48 offen lds
    s_add_u32 m0, s63, 8192
    s_add_u32 s48, s59, 66048
    buffer_load_dwordx4 v4, s[28:31], s48 offen lds
    s_add_u32 m0, s63, 12288
    s_add_u32 s48, s59, 98816
    buffer_load_dwordx4 v4, s[28:31], s48 offen lds
    s_waitcnt lgkmcnt(0)
    s_barrier
    ds_read_b128 v[16:19], v5 offset:0
    v_xor_b32 v6, 64, v5
    ds_read_b128 v[20:23], v6 offset:0
    v_xor_b32 v6, 128, v5
    ds_read_b128 v[24:27], v6 offset:0
    s_waitcnt lgkmcnt(2)
    v_mfma_f32_16x16x32_bf16 v[160:163], v[16:19], v[32:35], 0
    v_mfma_f32_16x16x32_bf16 v[164:167], v[16:19], v[36:39], 0
    v_xor_b32 v6, 192, v5
    v_mfma_f32_16x16x32_bf16 v[168:171], v[16:19], v[40:43], 0
    ds_read_b128 v[28:31], v6 offset:0
    v_mfma_f32_16x16x32_bf16 v[172:175], v[16:19], v[44:47], 0
    s_add_u32 m0, s63, 16384
    s_add_u32 s48, s59, 131584
    buffer_load_dwordx4 v4, s[28:31], s48 offen lds
    s_waitcnt lgkmcnt(2)
    v_mfma_f32_16x16x32_bf16 v[160:163], v[20:23], v[48:51], v[160:163]
    v_mfma_f32_16x16x32_bf16 v[164:167], v[20:23], v[52:55], v[164:167]
    v_xor_b32 v6, 256, v5
    v_mfma_f32_16x16x32_bf16 v[168:171], v[20:23], v[56:59], v[168:171]
    ds_read_b128 v[16:19], v6 offset:0
    v_mfma_f32_16x16x32_bf16 v[172:175], v[20:23], v[60:63], v[172:175]
    s_waitcnt lgkmcnt(2)
    v_mfma_f32_16x16x32_bf16 v[160:163], v[24:27], v[64:67], v[160:163]
    v_mfma_f32_16x16x32_bf16 v[164:167], v[24:27], v[68:71], v[164:167]
    v_xor_b32 v6, 320, v5
    v_mfma_f32_16x16x32_bf16 v[168:171], v[24:27], v[72:75], v[168:171]
    ds_read_b128 v[20:23], v6 offset:0
    v_mfma_f32_16x16x32_bf16 v[172:175], v[24:27], v[76:79], v[172:175]
    s_add_u32 m0, s63, 20480
    s_add_u32 s48, s59, 164352
    buffer_load_dwordx4 v4, s[28:31], s48 offen lds
    s_waitcnt lgkmcnt(2)
    v_mfma_f32_16x16x32_bf16 v[160:163], v[28:31], v[80:83], v[160:163]
    v_mfma_f32_16x16x32_bf16 v[164:167], v[28:31], v[84:87], v[164:167]
    v_xor_b32 v6, 384, v5
    v_mfma_f32_16x16x32_bf16 v[168:171], v[28:31], v[88:91], v[168:171]
    ds_read_b128 v[24:27], v6 offset:0
    v_mfma_f32_16x16x32_bf16 v[172:175], v[28:31], v[92:95], v[172:175]
    s_waitcnt lgkmcnt(2)
    v_mfma_f32_16x16x32_bf16 v[160:163], v[16:19], v[96:99], v[160:163]
    v_mfma_f32_16x16x32_bf16 v[164:167], v[16:19], v[100:103], v[164:167]
    v_xor_b32 v6, 448, v5
    v_mfma_f32_16x16x32_bf16 v[168:171], v[16:19], v[104:107], v[168:171]
    ds_read_b128 v[28:31], v6 offset:0
    v_mfma_f32_16x16x32_bf16 v[172:175], v[16:19], v[108:111], v[172:175]
    s_waitcnt lgkmcnt(0)
    s_barrier
    v_mfma_f32_16x16x32_bf16 v[160:163], v[20:23], v[112:115], v[160:163]
    v_mfma_f32_16x16x32_bf16 v[164:167], v[20:23], v[116:119], v[164:167]
    v_mfma_f32_16x16x32_bf16 v[168:171], v[20:23], v[120:123], v[168:171]
    ds_read_b128 v[16:19], v5 offset:8192
    v_mfma_f32_16x16x32_bf16 v[172:175], v[20:23], v[124:127], v[172:175]
    s_add_u32 m0, s63, 24576
    s_add_u32 s48, s59, 1024
    buffer_load_dwordx4 v4, s[28:31], s48 offen lds
    v_mfma_f32_16x16x32_bf16 v[160:163], v[24:27], v[128:131], v[160:163]
    v_mfma_f32_16x16x32_bf16 v[164:167], v[24:27], v[132:135], v[164:167]
    v_xor_b32 v6, 64, v5
    v_mfma_f32_16x16x32_bf16 v[168:171], v[24:27], v[136:139], v[168:171]
    ds_read_b128 v[20:23], v6 offset:8192
    v_mfma_f32_16x16x32_bf16 v[172:175], v[24:27], v[140:143], v[172:175]
    v_mfma_f32_16x16x32_bf16 v[160:163], v[28:31], v[144:147], v[160:163]
    v_mfma_f32_16x16x32_bf16 v[164:167], v[28:31], v[148:151], v[164:167]
    v_xor_b32 v6, 128, v5
    v_mfma_f32_16x16x32_bf16 v[168:171], v[28:31], v[152:155], v[168:171]
    ds_read_b128 v[24:27], v6 offset:8192
    v_mfma_f32_16x16x32_bf16 v[172:175], v[28:31], v[156:159], v[172:175]
    s_waitcnt lgkmcnt(2)
    v_mfma_f32_16x16x32_bf16 v[176:179], v[16:19], v[32:35], 0
    v_mfma_f32_16x16x32_bf16 v[180:183], v[16:19], v[36:39], 0
    v_xor_b32 v6, 192, v5
    v_mfma_f32_16x16x32_bf16 v[184:187], v[16:19], v[40:43], 0
    ds_read_b128 v[28:31], v6 offset:8192
    v_mfma_f32_16x16x32_bf16 v[188:191], v[16:19], v[44:47], 0
    s_waitcnt lgkmcnt(2)
    v_mfma_f32_16x16x32_bf16 v[176:179], v[20:23], v[48:51], v[176:179]
    v_mfma_f32_16x16x32_bf16 v[180:183], v[20:23], v[52:55], v[180:183]
    v_xor_b32 v6, 256, v5
    v_mfma_f32_16x16x32_bf16 v[184:187], v[20:23], v[56:59], v[184:187]
    ds_read_b128 v[16:19], v6 offset:8192
    v_mfma_f32_16x16x32_bf16 v[188:191], v[20:23], v[60:63], v[188:191]
    s_add_u32 m0, s63, 28672
    s_add_u32 s48, s59, 33792
    buffer_load_dwordx4 v4, s[28:31], s48 offen lds
    s_waitcnt lgkmcnt(2)
    v_mfma_f32_16x16x32_bf16 v[176:179], v[24:27], v[64:67], v[176:179]
    v_mfma_f32_16x16x32_bf16 v[180:183], v[24:27], v[68:71], v[180:183]
    v_xor_b32 v6, 320, v5
    v_mfma_f32_16x16x32_bf16 v[184:187], v[24:27], v[72:75], v[184:187]
    ds_read_b128 v[20:23], v6 offset:8192
    v_mfma_f32_16x16x32_bf16 v[188:191], v[24:27], v[76:79], v[188:191]
    s_waitcnt lgkmcnt(2)
    v_mfma_f32_16x16x32_bf16 v[176:179], v[28:31], v[80:83], v[176:179]
    v_mfma_f32_16x16x32_bf16 v[180:183], v[28:31], v[84:87], v[180:183]
    v_xor_b32 v6, 384, v5
    v_mfma_f32_16x16x32_bf16 v[184:187], v[28:31], v[88:91], v[184:187]
    ds_read_b128 v[24:27], v6 offset:8192
    v_mfma_f32_16x16x32_bf16 v[188:191], v[28:31], v[92:95], v[188:191]
    s_waitcnt lgkmcnt(2)
    v_mfma_f32_16x16x32_bf16 v[176:179], v[16:19], v[96:99], v[176:179]
    v_mfma_f32_16x16x32_bf16 v[180:183], v[16:19], v[100:103], v[180:183]
    v_xor_b32 v6, 448, v5
    v_mfma_f32_16x16x32_bf16 v[184:187], v[16:19], v[104:107], v[184:187]
    ds_read_b128 v[28:31], v6 offset:8192
    v_mfma_f32_16x16x32_bf16 v[188:191], v[16:19], v[108:111], v[188:191]
    s_waitcnt lgkmcnt(0)
    s_barrier
    v_mfma_f32_16x16x32_bf16 v[176:179], v[20:23], v[112:115], v[176:179]
    v_mfma_f32_16x16x32_bf16 v[180:183], v[20:23], v[116:119], v[180:183]
    v_mfma_f32_16x16x32_bf16 v[184:187], v[20:23], v[120:123], v[184:187]
    ds_read_b128 v[16:19], v5 offset:16384
    v_mfma_f32_16x16x32_bf16 v[188:191], v[20:23], v[124:127], v[188:191]
    v_mfma_f32_16x16x32_bf16 v[176:179], v[24:27], v[128:131], v[176:179]
    v_mfma_f32_16x16x32_bf16 v[180:183], v[24:27], v[132:135], v[180:183]
    v_xor_b32 v6, 64, v5
    v_mfma_f32_16x16x32_bf16 v[184:187], v[24:27], v[136:139], v[184:187]
    ds_read_b128 v[20:23], v6 offset:16384
    v_mfma_f32_16x16x32_bf16 v[188:191], v[24:27], v[140:143], v[188:191]
    s_add_u32 m0, s58, 73728
    s_min_u32 s48, s72, s73
    s_add_u32 s48, s48, 1024
    buffer_load_dwordx4 v3, s[36:39], s48 offen lds
    s_add_u32 m0, s58, 75776
    s_min_u32 s48, s72, s73
    s_add_u32 s48, s48, 4096
    buffer_load_dwordx4 v3, s[36:39], s48 offen lds
    v_mfma_f32_16x16x32_bf16 v[176:179], v[28:31], v[144:147], v[176:179]
    v_mfma_f32_16x16x32_bf16 v[180:183], v[28:31], v[148:151], v[180:183]
    v_xor_b32 v6, 128, v5
    v_mfma_f32_16x16x32_bf16 v[184:187], v[28:31], v[152:155], v[184:187]
    ds_read_b128 v[24:27], v6 offset:16384
    v_mfma_f32_16x16x32_bf16 v[188:191], v[28:31], v[156:159], v[188:191]
    s_waitcnt lgkmcnt(2)
    v_mfma_f32_16x16x32_bf16 v[192:195], v[16:19], v[32:35], 0
    v_mfma_f32_16x16x32_bf16 v[196:199], v[16:19], v[36:39], 0
    v_xor_b32 v6, 192, v5
    v_mfma_f32_16x16x32_bf16 v[200:203], v[16:19], v[40:43], 0
    ds_read_b128 v[28:31], v6 offset:16384
    v_mfma_f32_16x16x32_bf16 v[204:207], v[16:19], v[44:47], 0
    s_add_u32 m0, s58, 81920
    s_min_u32 s48, s72, s73
    s_add_u32 s48, s48, 13312
    buffer_load_dwordx4 v3, s[36:39], s48 offen lds
    s_add_u32 m0, s58, 83968
    s_min_u32 s48, s72, s73
    s_add_u32 s48, s48, 16384
    buffer_load_dwordx4 v3, s[36:39], s48 offen lds
    s_waitcnt lgkmcnt(2)
    v_mfma_f32_16x16x32_bf16 v[192:195], v[20:23], v[48:51], v[192:195]
    v_mfma_f32_16x16x32_bf16 v[196:199], v[20:23], v[52:55], v[196:199]
    v_xor_b32 v6, 256, v5
    v_mfma_f32_16x16x32_bf16 v[200:203], v[20:23], v[56:59], v[200:203]
    ds_read_b128 v[16:19], v6 offset:16384
    v_mfma_f32_16x16x32_bf16 v[204:207], v[20:23], v[60:63], v[204:207]
    s_waitcnt lgkmcnt(2)
    v_mfma_f32_16x16x32_bf16 v[192:195], v[24:27], v[64:67], v[192:195]
    v_mfma_f32_16x16x32_bf16 v[196:199], v[24:27], v[68:71], v[196:199]
    v_xor_b32 v6, 320, v5
    v_mfma_f32_16x16x32_bf16 v[200:203], v[24:27], v[72:75], v[200:203]
    ds_read_b128 v[20:23], v6 offset:16384
    v_mfma_f32_16x16x32_bf16 v[204:207], v[24:27], v[76:79], v[204:207]
    s_add_u32 m0, s58, 90112
    s_min_u32 s48, s74, s75
    s_add_u32 s48, s48, 1024
    buffer_load_dwordx4 v3, s[36:39], s48 offen lds
    s_add_u32 m0, s58, 92160
    s_min_u32 s48, s74, s75
    s_add_u32 s48, s48, 4096
    buffer_load_dwordx4 v3, s[36:39], s48 offen lds
    s_waitcnt lgkmcnt(2)
    v_mfma_f32_16x16x32_bf16 v[192:195], v[28:31], v[80:83], v[192:195]
    v_mfma_f32_16x16x32_bf16 v[196:199], v[28:31], v[84:87], v[196:199]
    v_xor_b32 v6, 384, v5
    v_mfma_f32_16x16x32_bf16 v[200:203], v[28:31], v[88:91], v[200:203]
    ds_read_b128 v[24:27], v6 offset:16384
    v_mfma_f32_16x16x32_bf16 v[204:207], v[28:31], v[92:95], v[204:207]
    s_waitcnt lgkmcnt(2)
    v_mfma_f32_16x16x32_bf16 v[192:195], v[16:19], v[96:99], v[192:195]
    v_mfma_f32_16x16x32_bf16 v[196:199], v[16:19], v[100:103], v[196:199]
    v_xor_b32 v6, 448, v5
    v_mfma_f32_16x16x32_bf16 v[200:203], v[16:19], v[104:107], v[200:203]
    ds_read_b128 v[28:31], v6 offset:16384
    v_mfma_f32_16x16x32_bf16 v[204:207], v[16:19], v[108:111], v[204:207]
    s_add_u32 m0, s58, 98304
    s_min_u32 s48, s74, s75
    s_add_u32 s48, s48, 13312
    buffer_load_dwordx4 v3, s[36:39], s48 offen lds
    s_add_u32 m0, s58, 100352
    s_min_u32 s48, s74, s75
    s_add_u32 s48, s48, 16384
    buffer_load_dwordx4 v3, s[36:39], s48 offen lds
    v_bfe_u32 v248, v0, 4, 2
    v_and_b32 v249, 15, v0
    v_and_b32 v250, 1, v249
    v_lshlrev_b32 v250, 5, v250
    v_lshrrev_b32 v251, 1, v249
    v_lshl_add_u32 v250, v251, 2, v250
    s_lshl_b32 s52, s61, 6
    v_add_u32 v250, s52, v250
    v_lshl_add_u32 v1, v248, 10, v250
    v_add_u32 v2, 49152, v1
    v_lshl_add_u32 v250, v248, 2, s57
    v_mul_u32_u24 v3, 640, v250
    v_lshl_add_u32 v3, v249, 4, v3
    s_and_b32 s52, s3, 1
    s_lshl_b32 s52, s52, 8
    v_add_u32 v3, s52, v3
    v_mov_b32 v250, 0x03020706
    v_mov_b32 v251, 0x05040100
    v_cndmask_b32 v4, v250, v251, s[80:81]
    s_waitcnt lgkmcnt(0)
    s_barrier
    v_mfma_f32_16x16x32_bf16 v[192:195], v[20:23], v[112:115], v[192:195]
    v_mfma_f32_16x16x32_bf16 v[196:199], v[20:23], v[116:119], v[196:199]
    v_mfma_f32_16x16x32_bf16 v[200:203], v[20:23], v[120:123], v[200:203]
    ds_read_b128 v[16:19], v5 offset:24576
    v_mfma_f32_16x16x32_bf16 v[204:207], v[20:23], v[124:127], v[204:207]
    v_mfma_f32_16x16x32_bf16 v[192:195], v[24:27], v[128:131], v[192:195]
    v_mfma_f32_16x16x32_bf16 v[196:199], v[24:27], v[132:135], v[196:199]
    v_xor_b32 v6, 64, v5
    v_mfma_f32_16x16x32_bf16 v[200:203], v[24:27], v[136:139], v[200:203]
    ds_read_b128 v[20:23], v6 offset:24576
    v_mfma_f32_16x16x32_bf16 v[204:207], v[24:27], v[140:143], v[204:207]
    v_mfma_f32_16x16x32_bf16 v[192:195], v[28:31], v[144:147], v[192:195]
    v_mfma_f32_16x16x32_bf16 v[196:199], v[28:31], v[148:151], v[196:199]
    v_xor_b32 v6, 128, v5
    v_mfma_f32_16x16x32_bf16 v[200:203], v[28:31], v[152:155], v[200:203]
    ds_read_b128 v[24:27], v6 offset:24576
    v_mfma_f32_16x16x32_bf16 v[204:207], v[28:31], v[156:159], v[204:207]
    s_waitcnt lgkmcnt(2)
    v_mfma_f32_16x16x32_bf16 v[208:211], v[16:19], v[32:35], 0
    v_mfma_f32_16x16x32_bf16 v[212:215], v[16:19], v[36:39], 0
    v_xor_b32 v6, 192, v5
    v_mfma_f32_16x16x32_bf16 v[216:219], v[16:19], v[40:43], 0
    ds_read_b128 v[28:31], v6 offset:24576
    v_mfma_f32_16x16x32_bf16 v[220:223], v[16:19], v[44:47], 0
    s_waitcnt lgkmcnt(2)
    v_mfma_f32_16x16x32_bf16 v[208:211], v[20:23], v[48:51], v[208:211]
    v_mfma_f32_16x16x32_bf16 v[212:215], v[20:23], v[52:55], v[212:215]
    v_xor_b32 v6, 256, v5
    v_mfma_f32_16x16x32_bf16 v[216:219], v[20:23], v[56:59], v[216:219]
    ds_read_b128 v[16:19], v6 offset:24576
    v_mfma_f32_16x16x32_bf16 v[220:223], v[20:23], v[60:63], v[220:223]
    s_waitcnt lgkmcnt(2)
    v_mfma_f32_16x16x32_bf16 v[208:211], v[24:27], v[64:67], v[208:211]
    v_mfma_f32_16x16x32_bf16 v[212:215], v[24:27], v[68:71], v[212:215]
    v_xor_b32 v6, 320, v5
    v_mfma_f32_16x16x32_bf16 v[216:219], v[24:27], v[72:75], v[216:219]
    ds_read_b128 v[20:23], v6 offset:24576
    v_mfma_f32_16x16x32_bf16 v[220:223], v[24:27], v[76:79], v[220:223]
    s_waitcnt lgkmcnt(2)
    v_mfma_f32_16x16x32_bf16 v[208:211], v[28:31], v[80:83], v[208:211]
    v_mfma_f32_16x16x32_bf16 v[212:215], v[28:31], v[84:87], v[212:215]
    v_xor_b32 v6, 384, v5
    v_mfma_f32_16x16x32_bf16 v[216:219], v[28:31], v[88:91], v[216:219]
    ds_read_b128 v[24:27], v6 offset:24576
    v_mfma_f32_16x16x32_bf16 v[220:223], v[28:31], v[92:95], v[220:223]
    s_waitcnt lgkmcnt(2)
    v_mfma_f32_16x16x32_bf16 v[208:211], v[16:19], v[96:99], v[208:211]
    v_mfma_f32_16x16x32_bf16 v[212:215], v[16:19], v[100:103], v[212:215]
    v_xor_b32 v6, 448, v5
    v_mfma_f32_16x16x32_bf16 v[216:219], v[16:19], v[104:107], v[216:219]
    ds_read_b128 v[28:31], v6 offset:24576
    v_mfma_f32_16x16x32_bf16 v[220:223], v[16:19], v[108:111], v[220:223]
    s_waitcnt lgkmcnt(0)
    s_waitcnt vmcnt(8)
    s_barrier
    ds_read_b32 v7, v1 offset:0
    ds_read_b32 v8, v1 offset:24576
    ds_read_b32 v9, v2 offset:0
    ds_read_b32 v10, v1 offset:256
    ds_read_b32 v12, v1 offset:24832
    ds_read_b32 v13, v2 offset:256
    ds_read_b32 v14, v1 offset:512
    ds_read_b32 v15, v1 offset:25088
    ds_read_b32 v254, v2 offset:512
    s_waitcnt lgkmcnt(6)
    v_perm_b32 v168, v172, v168, s56
    v_mov_b32_dpp v248, v164 quad_perm:[1,0,3,2] row_mask:0xf bank_mask:0xf
    v_mov_b32_dpp v249, v160 quad_perm:[1,0,3,2] row_mask:0xf bank_mask:0xf
    v_mov_b32_dpp v172, v168 quad_perm:[1,0,3,2] row_mask:0xf bank_mask:0xf
    v_cndmask_b32 v248, v248, v160, s[80:81]
    v_cndmask_b32 v249, v164, v249, s[80:81]
    v_perm_b32 v243, v172, v168, v4
    v_lshlrev_b32 v250, 16, v7
    v_lshlrev_b32 v251, 16, v8
    v_lshlrev_b32 v252, 16, v9
    v_and_b32 v7, 0xffff0000, v7
    v_and_b32 v8, 0xffff0000, v8
    v_and_b32 v9, 0xffff0000, v9
    v_mul_f32 v250, v250, v248
    v_mul_f32 v252, v252, v248
    v_mul_f32 v251, v251, v248
    v_mul_f32 v7, v7, v249
    v_mul_f32 v8, v8, v249
    v_mul_f32 v9, v9, v249
    v_add_u32 v250, s60, v250
    v_add_u32 v252, s60, v252
    v_perm_b32 v241, v8, v251, s56
    v_perm_b32 v240, v7, v250, s56
    v_perm_b32 v242, v9, v252, s56
    s_mov_b32 s52, 0
    buffer_store_dwordx4 v[240:243], v3, s[40:43], s52 offen offset:0 sc1
    ds_read_b32 v7, v1 offset:768
    ds_read_b32 v8, v1 offset:25344
    ds_read_b32 v9, v2 offset:768
    s_waitcnt lgkmcnt(6)
    v_perm_b32 v169, v173, v169, s56
    v_mov_b32_dpp v248, v165 quad_perm:[1,0,3,2] row_mask:0xf bank_mask:0xf
    v_mov_b32_dpp v249, v161 quad_perm:[1,0,3,2] row_mask:0xf bank_mask:0xf
    v_mov_b32_dpp v173, v169 quad_perm:[1,0,3,2] row_mask:0xf bank_mask:0xf
    v_cndmask_b32 v248, v248, v161, s[80:81]
    v_cndmask_b32 v249, v165, v249, s[80:81]
    v_perm_b32 v247, v173, v169, v4
    v_lshlrev_b32 v250, 16, v10
    v_lshlrev_b32 v251, 16, v12
    v_lshlrev_b32 v252, 16, v13
    v_and_b32 v10, 0xffff0000, v10
    v_and_b32 v12, 0xffff0000, v12
    v_and_b32 v13, 0xffff0000, v13
    v_mul_f32 v250, v250, v248
    v_mul_f32 v252, v252, v248
    v_mul_f32 v251, v251, v248
    v_mul_f32 v10, v10, v249
    v_mul_f32 v12, v12, v249
    v_mul_f32 v13, v13, v249
    v_add_u32 v250, s60, v250
    v_add_u32 v252, s60, v252
    v_perm_b32 v245, v12, v251, s56
    v_perm_b32 v244, v10, v250, s56
    v_perm_b32 v246, v13, v252, s56
    s_mov_b32 s52, 0
    buffer_store_dwordx4 v[244:247], v3, s[40:43], s52 offen offset:640 sc1
    ds_read_b32 v10, v1 offset:4096
    ds_read_b32 v12, v1 offset:28672
    ds_read_b32 v13, v2 offset:4096
    s_waitcnt lgkmcnt(6)
    v_perm_b32 v170, v174, v170, s56
    v_mov_b32_dpp v248, v166 quad_perm:[1,0,3,2] row_mask:0xf bank_mask:0xf
    v_mov_b32_dpp v249, v162 quad_perm:[1,0,3,2] row_mask:0xf bank_mask:0xf
    v_mov_b32_dpp v174, v170 quad_perm:[1,0,3,2] row_mask:0xf bank_mask:0xf
    v_cndmask_b32 v248, v248, v162, s[80:81]
    v_cndmask_b32 v249, v166, v249, s[80:81]
    v_perm_b32 v243, v174, v170, v4
    v_lshlrev_b32 v250, 16, v14
    v_lshlrev_b32 v251, 16, v15
    v_lshlrev_b32 v252, 16, v254
    v_and_b32 v14, 0xffff0000, v14
    v_and_b32 v15, 0xffff0000, v15
    v_and_b32 v254, 0xffff0000, v254
    v_mul_f32 v250, v250, v248
    v_mul_f32 v252, v252, v248
    v_mul_f32 v251, v251, v248
    v_mul_f32 v14, v14, v249
    v_mul_f32 v15, v15, v249
    v_mul_f32 v254, v254, v249
    v_add_u32 v250, s60, v250
    v_add_u32 v252, s60, v252
    v_perm_b32 v241, v15, v251, s56
    v_perm_b32 v240, v14, v250, s56
    v_perm_b32 v242, v254, v252, s56
    s_mov_b32 s52, 0
    buffer_store_dwordx4 v[240:243], v3, s[40:43], s52 offen offset:1280 sc1
    ds_read_b32 v14, v1 offset:4352
    ds_read_b32 v15, v1 offset:28928
    ds_read_b32 v254, v2 offset:4352
    s_waitcnt lgkmcnt(6)
    v_perm_b32 v171, v175, v171, s56
    v_mov_b32_dpp v248, v167 quad_perm:[1,0,3,2] row_mask:0xf bank_mask:0xf
    v_mov_b32_dpp v249, v163 quad_perm:[1,0,3,2] row_mask:0xf bank_mask:0xf
    v_mov_b32_dpp v175, v171 quad_perm:[1,0,3,2] row_mask:0xf bank_mask:0xf
    v_cndmask_b32 v248, v248, v163, s[80:81]
    v_cndmask_b32 v249, v167, v249, s[80:81]
    v_perm_b32 v247, v175, v171, v4
    v_lshlrev_b32 v250, 16, v7
    v_lshlrev_b32 v251, 16, v8
    v_lshlrev_b32 v252, 16, v9
    v_and_b32 v7, 0xffff0000, v7
    v_and_b32 v8, 0xffff0000, v8
    v_and_b32 v9, 0xffff0000, v9
    v_mul_f32 v250, v250, v248
    v_mul_f32 v252, v252, v248
    v_mul_f32 v251, v251, v248
    v_mul_f32 v7, v7, v249
    v_mul_f32 v8, v8, v249
    v_mul_f32 v9, v9, v249
    v_add_u32 v250, s60, v250
    v_add_u32 v252, s60, v252
    v_perm_b32 v245, v8, v251, s56
    v_perm_b32 v244, v7, v250, s56
    v_perm_b32 v246, v9, v252, s56
    s_mov_b32 s52, 0
    buffer_store_dwordx4 v[244:247], v3, s[40:43], s52 offen offset:1920 sc1
    ds_read_b32 v7, v1 offset:4608
    ds_read_b32 v8, v1 offset:29184
    ds_read_b32 v9, v2 offset:4608
    s_waitcnt lgkmcnt(6)
    v_perm_b32 v184, v188, v184, s56
    v_mov_b32_dpp v248, v180 quad_perm:[1,0,3,2] row_mask:0xf bank_mask:0xf
    v_mov_b32_dpp v249, v176 quad_perm:[1,0,3,2] row_mask:0xf bank_mask:0xf
    v_mov_b32_dpp v188, v184 quad_perm:[1,0,3,2] row_mask:0xf bank_mask:0xf
    v_cndmask_b32 v248, v248, v176, s[80:81]
    v_cndmask_b32 v249, v180, v249, s[80:81]
    v_perm_b32 v243, v188, v184, v4
    v_lshlrev_b32 v250, 16, v10
    v_lshlrev_b32 v251, 16, v12
    v_lshlrev_b32 v252, 16, v13
    v_and_b32 v10, 0xffff0000, v10
    v_and_b32 v12, 0xffff0000, v12
    v_and_b32 v13, 0xffff0000, v13
    v_mul_f32 v250, v250, v248
    v_mul_f32 v252, v252, v248
    v_mul_f32 v251, v251, v248
    v_mul_f32 v10, v10, v249
    v_mul_f32 v12, v12, v249
    v_mul_f32 v13, v13, v249
    v_add_u32 v250, s60, v250
    v_add_u32 v252, s60, v252
    v_perm_b32 v241, v12, v251, s56
    v_perm_b32 v240, v10, v250, s56
    v_perm_b32 v242, v13, v252, s56
    s_mov_b32 s52, 10240
    buffer_store_dwordx4 v[240:243], v3, s[40:43], s52 offen offset:0 sc1
    ds_read_b32 v10, v1 offset:4864
    ds_read_b32 v12, v1 offset:29440
    ds_read_b32 v13, v2 offset:4864
    s_waitcnt lgkmcnt(6)
    v_perm_b32 v185, v189, v185, s56
    v_mov_b32_dpp v248, v181 quad_perm:[1,0,3,2] row_mask:0xf bank_mask:0xf
    v_mov_b32_dpp v249, v177 quad_perm:[1,0,3,2] row_mask:0xf bank_mask:0xf
    v_mov_b32_dpp v189, v185 quad_perm:[1,0,3,2] row_mask:0xf bank_mask:0xf
    v_cndmask_b32 v248, v248, v177, s[80:81]
    v_cndmask_b32 v249, v181, v249, s[80:81]
    v_perm_b32 v247, v189, v185, v4
    v_lshlrev_b32 v250, 16, v14
    v_lshlrev_b32 v251, 16, v15
    v_lshlrev_b32 v252, 16, v254
    v_and_b32 v14, 0xffff0000, v14
    v_and_b32 v15, 0xffff0000, v15
    v_and_b32 v254, 0xffff0000, v254
    v_mul_f32 v250, v250, v248
    v_mul_f32 v252, v252, v248
    v_mul_f32 v251, v251, v248
    v_mul_f32 v14, v14, v249
    v_mul_f32 v15, v15, v249
    v_mul_f32 v254, v254, v249
    v_add_u32 v250, s60, v250
    v_add_u32 v252, s60, v252
    v_perm_b32 v245, v15, v251, s56
    v_perm_b32 v244, v14, v250, s56
    v_perm_b32 v246, v254, v252, s56
    s_mov_b32 s52, 10240
    buffer_store_dwordx4 v[244:247], v3, s[40:43], s52 offen offset:640 sc1
    ds_read_b32 v14, v1 offset:8192
    ds_read_b32 v15, v1 offset:32768
    ds_read_b32 v254, v2 offset:8192
    s_waitcnt lgkmcnt(6)
    v_perm_b32 v186, v190, v186, s56
    v_mov_b32_dpp v248, v182 quad_perm:[1,0,3,2] row_mask:0xf bank_mask:0xf
    v_mov_b32_dpp v249, v178 quad_perm:[1,0,3,2] row_mask:0xf bank_mask:0xf
    v_mov_b32_dpp v190, v186 quad_perm:[1,0,3,2] row_mask:0xf bank_mask:0xf
    v_cndmask_b32 v248, v248, v178, s[80:81]
    v_cndmask_b32 v249, v182, v249, s[80:81]
    v_perm_b32 v243, v190, v186, v4
    v_lshlrev_b32 v250, 16, v7
    v_lshlrev_b32 v251, 16, v8
    v_lshlrev_b32 v252, 16, v9
    v_and_b32 v7, 0xffff0000, v7
    v_and_b32 v8, 0xffff0000, v8
    v_and_b32 v9, 0xffff0000, v9
    v_mul_f32 v250, v250, v248
    v_mul_f32 v252, v252, v248
    v_mul_f32 v251, v251, v248
    v_mul_f32 v7, v7, v249
    v_mul_f32 v8, v8, v249
    v_mul_f32 v9, v9, v249
    v_add_u32 v250, s60, v250
    v_add_u32 v252, s60, v252
    v_perm_b32 v241, v8, v251, s56
    v_perm_b32 v240, v7, v250, s56
    v_perm_b32 v242, v9, v252, s56
    s_mov_b32 s52, 10240
    buffer_store_dwordx4 v[240:243], v3, s[40:43], s52 offen offset:1280 sc1
    ds_read_b32 v7, v1 offset:8448
    ds_read_b32 v8, v1 offset:33024
    ds_read_b32 v9, v2 offset:8448
    s_waitcnt lgkmcnt(6)
    v_perm_b32 v187, v191, v187, s56
    v_mov_b32_dpp v248, v183 quad_perm:[1,0,3,2] row_mask:0xf bank_mask:0xf
    v_mov_b32_dpp v249, v179 quad_perm:[1,0,3,2] row_mask:0xf bank_mask:0xf
    v_mov_b32_dpp v191, v187 quad_perm:[1,0,3,2] row_mask:0xf bank_mask:0xf
    v_cndmask_b32 v248, v248, v179, s[80:81]
    v_cndmask_b32 v249, v183, v249, s[80:81]
    v_perm_b32 v247, v191, v187, v4
    v_lshlrev_b32 v250, 16, v10
    v_lshlrev_b32 v251, 16, v12
    v_lshlrev_b32 v252, 16, v13
    v_and_b32 v10, 0xffff0000, v10
    v_and_b32 v12, 0xffff0000, v12
    v_and_b32 v13, 0xffff0000, v13
    v_mul_f32 v250, v250, v248
    v_mul_f32 v252, v252, v248
    v_mul_f32 v251, v251, v248
    v_mul_f32 v10, v10, v249
    v_mul_f32 v12, v12, v249
    v_mul_f32 v13, v13, v249
    v_add_u32 v250, s60, v250
    v_add_u32 v252, s60, v252
    v_perm_b32 v245, v12, v251, s56
    v_perm_b32 v244, v10, v250, s56
    v_perm_b32 v246, v13, v252, s56
    s_mov_b32 s52, 10240
    buffer_store_dwordx4 v[244:247], v3, s[40:43], s52 offen offset:1920 sc1
    v_mfma_f32_16x16x32_bf16 v[208:211], v[20:23], v[112:115], v[208:211]
    v_mfma_f32_16x16x32_bf16 v[212:215], v[20:23], v[116:119], v[212:215]
    v_mfma_f32_16x16x32_bf16 v[216:219], v[20:23], v[120:123], v[216:219]
    ds_read_b128 v[16:19], v5 offset:32768
    v_mfma_f32_16x16x32_bf16 v[220:223], v[20:23], v[124:127], v[220:223]
    v_mfma_f32_16x16x32_bf16 v[208:211], v[24:27], v[128:131], v[208:211]
    v_mfma_f32_16x16x32_bf16 v[212:215], v[24:27], v[132:135], v[212:215]
    v_xor_b32 v6, 64, v5
    v_mfma_f32_16x16x32_bf16 v[216:219], v[24:27], v[136:139], v[216:219]
    ds_read_b128 v[20:23], v6 offset:32768
    v_mfma_f32_16x16x32_bf16 v[220:223], v[24:27], v[140:143], v[220:223]
    v_mfma_f32_16x16x32_bf16 v[208:211], v[28:31], v[144:147], v[208:211]
    v_mfma_f32_16x16x32_bf16 v[212:215], v[28:31], v[148:151], v[212:215]
    v_xor_b32 v6, 128, v5
    v_mfma_f32_16x16x32_bf16 v[216:219], v[28:31], v[152:155], v[216:219]
    ds_read_b128 v[24:27], v6 offset:32768
    v_mfma_f32_16x16x32_bf16 v[220:223], v[28:31], v[156:159], v[220:223]
    s_waitcnt lgkmcnt(2)
    v_mfma_f32_16x16x32_bf16 v[224:227], v[16:19], v[32:35], 0
    v_mfma_f32_16x16x32_bf16 v[228:231], v[16:19], v[36:39], 0
    v_xor_b32 v6, 192, v5
    v_mfma_f32_16x16x32_bf16 v[232:235], v[16:19], v[40:43], 0
    ds_read_b128 v[28:31], v6 offset:32768
    v_mfma_f32_16x16x32_bf16 v[236:239], v[16:19], v[44:47], 0
    s_waitcnt lgkmcnt(2)
    v_mfma_f32_16x16x32_bf16 v[224:227], v[20:23], v[48:51], v[224:227]
    v_mfma_f32_16x16x32_bf16 v[228:231], v[20:23], v[52:55], v[228:231]
    v_xor_b32 v6, 256, v5
    v_mfma_f32_16x16x32_bf16 v[232:235], v[20:23], v[56:59], v[232:235]
    ds_read_b128 v[16:19], v6 offset:32768
    v_mfma_f32_16x16x32_bf16 v[236:239], v[20:23], v[60:63], v[236:239]
    s_waitcnt lgkmcnt(2)
    v_mfma_f32_16x16x32_bf16 v[224:227], v[24:27], v[64:67], v[224:227]
    v_mfma_f32_16x16x32_bf16 v[228:231], v[24:27], v[68:71], v[228:231]
    v_xor_b32 v6, 320, v5
    v_mfma_f32_16x16x32_bf16 v[232:235], v[24:27], v[72:75], v[232:235]
    ds_read_b128 v[20:23], v6 offset:32768
    v_mfma_f32_16x16x32_bf16 v[236:239], v[24:27], v[76:79], v[236:239]
    s_waitcnt lgkmcnt(2)
    v_mfma_f32_16x16x32_bf16 v[224:227], v[28:31], v[80:83], v[224:227]
    v_mfma_f32_16x16x32_bf16 v[228:231], v[28:31], v[84:87], v[228:231]
    v_xor_b32 v6, 384, v5
    v_mfma_f32_16x16x32_bf16 v[232:235], v[28:31], v[88:91], v[232:235]
    ds_read_b128 v[24:27], v6 offset:32768
    v_mfma_f32_16x16x32_bf16 v[236:239], v[28:31], v[92:95], v[236:239]
    s_waitcnt lgkmcnt(2)
    v_mfma_f32_16x16x32_bf16 v[224:227], v[16:19], v[96:99], v[224:227]
    v_mfma_f32_16x16x32_bf16 v[228:231], v[16:19], v[100:103], v[228:231]
    v_xor_b32 v6, 448, v5
    v_mfma_f32_16x16x32_bf16 v[232:235], v[16:19], v[104:107], v[232:235]
    ds_read_b128 v[28:31], v6 offset:32768
    v_mfma_f32_16x16x32_bf16 v[236:239], v[16:19], v[108:111], v[236:239]
    s_waitcnt lgkmcnt(0)
    s_waitcnt vmcnt(8)
    s_barrier
    ds_read_b32 v10, v1 offset:8704
    ds_read_b32 v12, v1 offset:33280
    ds_read_b32 v13, v2 offset:8704
    s_waitcnt lgkmcnt(6)
    v_perm_b32 v200, v204, v200, s56
    v_mov_b32_dpp v248, v196 quad_perm:[1,0,3,2] row_mask:0xf bank_mask:0xf
    v_mov_b32_dpp v249, v192 quad_perm:[1,0,3,2] row_mask:0xf bank_mask:0xf
    v_mov_b32_dpp v204, v200 quad_perm:[1,0,3,2] row_mask:0xf bank_mask:0xf
    v_cndmask_b32 v248, v248, v192, s[80:81]
    v_cndmask_b32 v249, v196, v249, s[80:81]
    v_perm_b32 v243, v204, v200, v4
    v_lshlrev_b32 v250, 16, v14
    v_lshlrev_b32 v251, 16, v15
    v_lshlrev_b32 v252, 16, v254
    v_and_b32 v14, 0xffff0000, v14
    v_and_b32 v15, 0xffff0000, v15
    v_and_b32 v254, 0xffff0000, v254
    v_mul_f32 v250, v250, v248
    v_mul_f32 v252, v252, v248
    v_mul_f32 v251, v251, v248
    v_mul_f32 v14, v14, v249
    v_mul_f32 v15, v15, v249
    v_mul_f32 v254, v254, v249
    v_add_u32 v250, s60, v250
    v_add_u32 v252, s60, v252
    v_perm_b32 v241, v15, v251, s56
    v_perm_b32 v240, v14, v250, s56
    v_perm_b32 v242, v254, v252, s56
    s_mov_b32 s52, 20480
    buffer_store_dwordx4 v[240:243], v3, s[40:43], s52 offen offset:0 sc1
    ds_read_b32 v14, v1 offset:8960
    ds_read_b32 v15, v1 offset:33536
    ds_read_b32 v254, v2 offset:8960
    s_waitcnt lgkmcnt(6)
    v_perm_b32 v201, v205, v201, s56
    v_mov_b32_dpp v248, v197 quad_perm:[1,0,3,2] row_mask:0xf bank_mask:0xf
    v_mov_b32_dpp v249, v193 quad_perm:[1,0,3,2] row_mask:0xf bank_mask:0xf
    v_mov_b32_dpp v205, v201 quad_perm:[1,0,3,2] row_mask:0xf bank_mask:0xf
    v_cndmask_b32 v248, v248, v193, s[80:81]
    v_cndmask_b32 v249, v197, v249, s[80:81]
    v_perm_b32 v247, v205, v201, v4
    v_lshlrev_b32 v250, 16, v7
    v_lshlrev_b32 v251, 16, v8
    v_lshlrev_b32 v252, 16, v9
    v_and_b32 v7, 0xffff0000, v7
    v_and_b32 v8, 0xffff0000, v8
    v_and_b32 v9, 0xffff0000, v9
    v_mul_f32 v250, v250, v248
    v_mul_f32 v252, v252, v248
    v_mul_f32 v251, v251, v248
    v_mul_f32 v7, v7, v249
    v_mul_f32 v8, v8, v249
    v_mul_f32 v9, v9, v249
    v_add_u32 v250, s60, v250
    v_add_u32 v252, s60, v252
    v_perm_b32 v245, v8, v251, s56
    v_perm_b32 v244, v7, v250, s56
    v_perm_b32 v246, v9, v252, s56
    s_mov_b32 s52, 20480
    buffer_store_dwordx4 v[244:247], v3, s[40:43], s52 offen offset:640 sc1
    ds_read_b32 v7, v1 offset:12288
    ds_read_b32 v8, v1 offset:36864
    ds_read_b32 v9, v2 offset:12288
    s_waitcnt lgkmcnt(6)
    v_perm_b32 v202, v206, v202, s56
    v_mov_b32_dpp v248, v198 quad_perm:[1,0,3,2] row_mask:0xf bank_mask:0xf
    v_mov_b32_dpp v249, v194 quad_perm:[1,0,3,2] row_mask:0xf bank_mask:0xf
    v_mov_b32_dpp v206, v202 quad_perm:[1,0,3,2] row_mask:0xf bank_mask:0xf
    v_cndmask_b32 v248, v248, v194, s[80:81]
    v_cndmask_b32 v249, v198, v249, s[80:81]
    v_perm_b32 v243, v206, v202, v4
    v_lshlrev_b32 v250, 16, v10
    v_lshlrev_b32 v251, 16, v12
    v_lshlrev_b32 v252, 16, v13
    v_and_b32 v10, 0xffff0000, v10
    v_and_b32 v12, 0xffff0000, v12
    v_and_b32 v13, 0xffff0000, v13
    v_mul_f32 v250, v250, v248
    v_mul_f32 v252, v252, v248
    v_mul_f32 v251, v251, v248
    v_mul_f32 v10, v10, v249
    v_mul_f32 v12, v12, v249
    v_mul_f32 v13, v13, v249
    v_add_u32 v250, s60, v250
    v_add_u32 v252, s60, v252
    v_perm_b32 v241, v12, v251, s56
    v_perm_b32 v240, v10, v250, s56
    v_perm_b32 v242, v13, v252, s56
    s_mov_b32 s52, 20480
    buffer_store_dwordx4 v[240:243], v3, s[40:43], s52 offen offset:1280 sc1
    ds_read_b32 v10, v1 offset:12544
    ds_read_b32 v12, v1 offset:37120
    ds_read_b32 v13, v2 offset:12544
    s_waitcnt lgkmcnt(6)
    v_perm_b32 v203, v207, v203, s56
    v_mov_b32_dpp v248, v199 quad_perm:[1,0,3,2] row_mask:0xf bank_mask:0xf
    v_mov_b32_dpp v249, v195 quad_perm:[1,0,3,2] row_mask:0xf bank_mask:0xf
    v_mov_b32_dpp v207, v203 quad_perm:[1,0,3,2] row_mask:0xf bank_mask:0xf
    v_cndmask_b32 v248, v248, v195, s[80:81]
    v_cndmask_b32 v249, v199, v249, s[80:81]
    v_perm_b32 v247, v207, v203, v4
    v_lshlrev_b32 v250, 16, v14
    v_lshlrev_b32 v251, 16, v15
    v_lshlrev_b32 v252, 16, v254
    v_and_b32 v14, 0xffff0000, v14
    v_and_b32 v15, 0xffff0000, v15
    v_and_b32 v254, 0xffff0000, v254
    v_mul_f32 v250, v250, v248
    v_mul_f32 v252, v252, v248
    v_mul_f32 v251, v251, v248
    v_mul_f32 v14, v14, v249
    v_mul_f32 v15, v15, v249
    v_mul_f32 v254, v254, v249
    v_add_u32 v250, s60, v250
    v_add_u32 v252, s60, v252
    v_perm_b32 v245, v15, v251, s56
    v_perm_b32 v244, v14, v250, s56
    v_perm_b32 v246, v254, v252, s56
    s_mov_b32 s52, 20480
    buffer_store_dwordx4 v[244:247], v3, s[40:43], s52 offen offset:1920 sc1
    ds_read_b32 v14, v1 offset:12800
    ds_read_b32 v15, v1 offset:37376
    ds_read_b32 v254, v2 offset:12800
    s_waitcnt lgkmcnt(6)
    v_perm_b32 v216, v220, v216, s56
    v_mov_b32_dpp v248, v212 quad_perm:[1,0,3,2] row_mask:0xf bank_mask:0xf
    v_mov_b32_dpp v249, v208 quad_perm:[1,0,3,2] row_mask:0xf bank_mask:0xf
    v_mov_b32_dpp v220, v216 quad_perm:[1,0,3,2] row_mask:0xf bank_mask:0xf
    v_cndmask_b32 v248, v248, v208, s[80:81]
    v_cndmask_b32 v249, v212, v249, s[80:81]
    v_perm_b32 v243, v220, v216, v4
    v_lshlrev_b32 v250, 16, v7
    v_lshlrev_b32 v251, 16, v8
    v_lshlrev_b32 v252, 16, v9
    v_and_b32 v7, 0xffff0000, v7
    v_and_b32 v8, 0xffff0000, v8
    v_and_b32 v9, 0xffff0000, v9
    v_mul_f32 v250, v250, v248
    v_mul_f32 v252, v252, v248
    v_mul_f32 v251, v251, v248
    v_mul_f32 v7, v7, v249
    v_mul_f32 v8, v8, v249
    v_mul_f32 v9, v9, v249
    v_add_u32 v250, s60, v250
    v_add_u32 v252, s60, v252
    v_perm_b32 v241, v8, v251, s56
    v_perm_b32 v240, v7, v250, s56
    v_perm_b32 v242, v9, v252, s56
    s_mov_b32 s52, 30720
    buffer_store_dwordx4 v[240:243], v3, s[40:43], s52 offen offset:0 sc1
    ds_read_b32 v7, v1 offset:13056
    ds_read_b32 v8, v1 offset:37632
    ds_read_b32 v9, v2 offset:13056
    s_waitcnt lgkmcnt(6)
    v_perm_b32 v217, v221, v217, s56
    v_mov_b32_dpp v248, v213 quad_perm:[1,0,3,2] row_mask:0xf bank_mask:0xf
    v_mov_b32_dpp v249, v209 quad_perm:[1,0,3,2] row_mask:0xf bank_mask:0xf
    v_mov_b32_dpp v221, v217 quad_perm:[1,0,3,2] row_mask:0xf bank_mask:0xf
    v_cndmask_b32 v248, v248, v209, s[80:81]
    v_cndmask_b32 v249, v213, v249, s[80:81]
    v_perm_b32 v247, v221, v217, v4
    v_lshlrev_b32 v250, 16, v10
    v_lshlrev_b32 v251, 16, v12
    v_lshlrev_b32 v252, 16, v13
    v_and_b32 v10, 0xffff0000, v10
    v_and_b32 v12, 0xffff0000, v12
    v_and_b32 v13, 0xffff0000, v13
    v_mul_f32 v250, v250, v248
    v_mul_f32 v252, v252, v248
    v_mul_f32 v251, v251, v248
    v_mul_f32 v10, v10, v249
    v_mul_f32 v12, v12, v249
    v_mul_f32 v13, v13, v249
    v_add_u32 v250, s60, v250
    v_add_u32 v252, s60, v252
    v_perm_b32 v245, v12, v251, s56
    v_perm_b32 v244, v10, v250, s56
    v_perm_b32 v246, v13, v252, s56
    s_mov_b32 s52, 30720
    buffer_store_dwordx4 v[244:247], v3, s[40:43], s52 offen offset:640 sc1
    v_mfma_f32_16x16x32_bf16 v[224:227], v[20:23], v[112:115], v[224:227]
    v_mfma_f32_16x16x32_bf16 v[228:231], v[20:23], v[116:119], v[228:231]
    v_mfma_f32_16x16x32_bf16 v[232:235], v[20:23], v[120:123], v[232:235]
    ds_read_b128 v[16:19], v5 offset:40960
    v_mfma_f32_16x16x32_bf16 v[236:239], v[20:23], v[124:127], v[236:239]
    v_mfma_f32_16x16x32_bf16 v[224:227], v[24:27], v[128:131], v[224:227]
    v_mfma_f32_16x16x32_bf16 v[228:231], v[24:27], v[132:135], v[228:231]
    v_xor_b32 v6, 64, v5
    v_mfma_f32_16x16x32_bf16 v[232:235], v[24:27], v[136:139], v[232:235]
    ds_read_b128 v[20:23], v6 offset:40960
    v_mfma_f32_16x16x32_bf16 v[236:239], v[24:27], v[140:143], v[236:239]
    v_mfma_f32_16x16x32_bf16 v[224:227], v[28:31], v[144:147], v[224:227]
    v_mfma_f32_16x16x32_bf16 v[228:231], v[28:31], v[148:151], v[228:231]
    v_xor_b32 v6, 128, v5
    v_mfma_f32_16x16x32_bf16 v[232:235], v[28:31], v[152:155], v[232:235]
    ds_read_b128 v[24:27], v6 offset:40960
    v_mfma_f32_16x16x32_bf16 v[236:239], v[28:31], v[156:159], v[236:239]
    s_waitcnt lgkmcnt(2)
    v_mfma_f32_16x16x32_bf16 v[160:163], v[16:19], v[32:35], 0
    v_mfma_f32_16x16x32_bf16 v[164:167], v[16:19], v[36:39], 0
    v_xor_b32 v6, 192, v5
    v_mfma_f32_16x16x32_bf16 v[168:171], v[16:19], v[40:43], 0
    ds_read_b128 v[28:31], v6 offset:40960
    v_mfma_f32_16x16x32_bf16 v[172:175], v[16:19], v[44:47], 0
    s_waitcnt lgkmcnt(2)
    v_mfma_f32_16x16x32_bf16 v[160:163], v[20:23], v[48:51], v[160:163]
    v_mfma_f32_16x16x32_bf16 v[164:167], v[20:23], v[52:55], v[164:167]
    v_xor_b32 v6, 256, v5
    v_mfma_f32_16x16x32_bf16 v[168:171], v[20:23], v[56:59], v[168:171]
    ds_read_b128 v[16:19], v6 offset:40960
    v_mfma_f32_16x16x32_bf16 v[172:175], v[20:23], v[60:63], v[172:175]
    s_waitcnt lgkmcnt(2)
    v_mfma_f32_16x16x32_bf16 v[160:163], v[24:27], v[64:67], v[160:163]
    v_mfma_f32_16x16x32_bf16 v[164:167], v[24:27], v[68:71], v[164:167]
    v_xor_b32 v6, 320, v5
    v_mfma_f32_16x16x32_bf16 v[168:171], v[24:27], v[72:75], v[168:171]
    ds_read_b128 v[20:23], v6 offset:40960
    v_mfma_f32_16x16x32_bf16 v[172:175], v[24:27], v[76:79], v[172:175]
    s_waitcnt lgkmcnt(2)
    v_mfma_f32_16x16x32_bf16 v[160:163], v[28:31], v[80:83], v[160:163]
    v_mfma_f32_16x16x32_bf16 v[164:167], v[28:31], v[84:87], v[164:167]
    v_xor_b32 v6, 384, v5
    v_mfma_f32_16x16x32_bf16 v[168:171], v[28:31], v[88:91], v[168:171]
    ds_read_b128 v[24:27], v6 offset:40960
    v_mfma_f32_16x16x32_bf16 v[172:175], v[28:31], v[92:95], v[172:175]
    s_waitcnt lgkmcnt(2)
    v_mfma_f32_16x16x32_bf16 v[160:163], v[16:19], v[96:99], v[160:163]
    v_mfma_f32_16x16x32_bf16 v[164:167], v[16:19], v[100:103], v[164:167]
    v_xor_b32 v6, 448, v5
    v_mfma_f32_16x16x32_bf16 v[168:171], v[16:19], v[104:107], v[168:171]
    ds_read_b128 v[28:31], v6 offset:40960
    v_mfma_f32_16x16x32_bf16 v[172:175], v[16:19], v[108:111], v[172:175]
    s_waitcnt lgkmcnt(2)
    v_mfma_f32_16x16x32_bf16 v[160:163], v[20:23], v[112:115], v[160:163]
    v_mfma_f32_16x16x32_bf16 v[164:167], v[20:23], v[116:119], v[164:167]
    v_mfma_f32_16x16x32_bf16 v[168:171], v[20:23], v[120:123], v[168:171]
    v_mfma_f32_16x16x32_bf16 v[172:175], v[20:23], v[124:127], v[172:175]
    s_waitcnt lgkmcnt(1)
    v_mfma_f32_16x16x32_bf16 v[160:163], v[24:27], v[128:131], v[160:163]
    v_mfma_f32_16x16x32_bf16 v[164:167], v[24:27], v[132:135], v[164:167]
    v_mfma_f32_16x16x32_bf16 v[168:171], v[24:27], v[136:139], v[168:171]
    v_mfma_f32_16x16x32_bf16 v[172:175], v[24:27], v[140:143], v[172:175]
    s_waitcnt lgkmcnt(0)
    v_mfma_f32_16x16x32_bf16 v[160:163], v[28:31], v[144:147], v[160:163]
    v_mfma_f32_16x16x32_bf16 v[164:167], v[28:31], v[148:151], v[164:167]
    v_mfma_f32_16x16x32_bf16 v[168:171], v[28:31], v[152:155], v[168:171]
    v_mfma_f32_16x16x32_bf16 v[172:175], v[28:31], v[156:159], v[172:175]
    s_waitcnt lgkmcnt(0)
    s_barrier
    ds_read_b32 v10, v1 offset:16384
    ds_read_b32 v12, v1 offset:40960
    ds_read_b32 v13, v2 offset:16384
    s_waitcnt lgkmcnt(6)
    v_perm_b32 v218, v222, v218, s56
    v_mov_b32_dpp v248, v214 quad_perm:[1,0,3,2] row_mask:0xf bank_mask:0xf
    v_mov_b32_dpp v249, v210 quad_perm:[1,0,3,2] row_mask:0xf bank_mask:0xf
    v_mov_b32_dpp v222, v218 quad_perm:[1,0,3,2] row_mask:0xf bank_mask:0xf
    v_cndmask_b32 v248, v248, v210, s[80:81]
    v_cndmask_b32 v249, v214, v249, s[80:81]
    v_perm_b32 v243, v222, v218, v4
    v_lshlrev_b32 v250, 16, v14
    v_lshlrev_b32 v251, 16, v15
    v_lshlrev_b32 v252, 16, v254
    v_and_b32 v14, 0xffff0000, v14
    v_and_b32 v15, 0xffff0000, v15
    v_and_b32 v254, 0xffff0000, v254
    v_mul_f32 v250, v250, v248
    v_mul_f32 v252, v252, v248
    v_mul_f32 v251, v251, v248
    v_mul_f32 v14, v14, v249
    v_mul_f32 v15, v15, v249
    v_mul_f32 v254, v254, v249
    v_add_u32 v250, s60, v250
    v_add_u32 v252, s60, v252
    v_perm_b32 v241, v15, v251, s56
    v_perm_b32 v240, v14, v250, s56
    v_perm_b32 v242, v254, v252, s56
    s_mov_b32 s52, 30720
    buffer_store_dwordx4 v[240:243], v3, s[40:43], s52 offen offset:1280 sc1
    ds_read_b32 v14, v1 offset:16640
    ds_read_b32 v15, v1 offset:41216
    ds_read_b32 v254, v2 offset:16640
    s_waitcnt lgkmcnt(6)
    v_perm_b32 v219, v223, v219, s56
    v_mov_b32_dpp v248, v215 quad_perm:[1,0,3,2] row_mask:0xf bank_mask:0xf
    v_mov_b32_dpp v249, v211 quad_perm:[1,0,3,2] row_mask:0xf bank_mask:0xf
    v_mov_b32_dpp v223, v219 quad_perm:[1,0,3,2] row_mask:0xf bank_mask:0xf
    v_cndmask_b32 v248, v248, v211, s[80:81]
    v_cndmask_b32 v249, v215, v249, s[80:81]
    v_perm_b32 v247, v223, v219, v4
    v_lshlrev_b32 v250, 16, v7
    v_lshlrev_b32 v251, 16, v8
    v_lshlrev_b32 v252, 16, v9
    v_and_b32 v7, 0xffff0000, v7
    v_and_b32 v8, 0xffff0000, v8
    v_and_b32 v9, 0xffff0000, v9
    v_mul_f32 v250, v250, v248
    v_mul_f32 v252, v252, v248
    v_mul_f32 v251, v251, v248
    v_mul_f32 v7, v7, v249
    v_mul_f32 v8, v8, v249
    v_mul_f32 v9, v9, v249
    v_add_u32 v250, s60, v250
    v_add_u32 v252, s60, v252
    v_perm_b32 v245, v8, v251, s56
    v_perm_b32 v244, v7, v250, s56
    v_perm_b32 v246, v9, v252, s56
    s_mov_b32 s52, 30720
    buffer_store_dwordx4 v[244:247], v3, s[40:43], s52 offen offset:1920 sc1
    ds_read_b32 v7, v1 offset:16896
    ds_read_b32 v8, v1 offset:41472
    ds_read_b32 v9, v2 offset:16896
    s_waitcnt lgkmcnt(6)
    v_perm_b32 v232, v236, v232, s56
    v_mov_b32_dpp v248, v228 quad_perm:[1,0,3,2] row_mask:0xf bank_mask:0xf
    v_mov_b32_dpp v249, v224 quad_perm:[1,0,3,2] row_mask:0xf bank_mask:0xf
    v_mov_b32_dpp v236, v232 quad_perm:[1,0,3,2] row_mask:0xf bank_mask:0xf
    v_cndmask_b32 v248, v248, v224, s[80:81]
    v_cndmask_b32 v249, v228, v249, s[80:81]
    v_perm_b32 v243, v236, v232, v4
    v_lshlrev_b32 v250, 16, v10
    v_lshlrev_b32 v251, 16, v12
    v_lshlrev_b32 v252, 16, v13
    v_and_b32 v10, 0xffff0000, v10
    v_and_b32 v12, 0xffff0000, v12
    v_and_b32 v13, 0xffff0000, v13
    v_mul_f32 v250, v250, v248
    v_mul_f32 v252, v252, v248
    v_mul_f32 v251, v251, v248
    v_mul_f32 v10, v10, v249
    v_mul_f32 v12, v12, v249
    v_mul_f32 v13, v13, v249
    v_add_u32 v250, s60, v250
    v_add_u32 v252, s60, v252
    v_perm_b32 v241, v12, v251, s56
    v_perm_b32 v240, v10, v250, s56
    v_perm_b32 v242, v13, v252, s56
    s_mov_b32 s52, 40960
    buffer_store_dwordx4 v[240:243], v3, s[40:43], s52 offen offset:0 sc1
    ds_read_b32 v10, v1 offset:17152
    ds_read_b32 v12, v1 offset:41728
    ds_read_b32 v13, v2 offset:17152
    s_waitcnt lgkmcnt(6)
    v_perm_b32 v233, v237, v233, s56
    v_mov_b32_dpp v248, v229 quad_perm:[1,0,3,2] row_mask:0xf bank_mask:0xf
    v_mov_b32_dpp v249, v225 quad_perm:[1,0,3,2] row_mask:0xf bank_mask:0xf
    v_mov_b32_dpp v237, v233 quad_perm:[1,0,3,2] row_mask:0xf bank_mask:0xf
    v_cndmask_b32 v248, v248, v225, s[80:81]
    v_cndmask_b32 v249, v229, v249, s[80:81]
    v_perm_b32 v247, v237, v233, v4
    v_lshlrev_b32 v250, 16, v14
    v_lshlrev_b32 v251, 16, v15
    v_lshlrev_b32 v252, 16, v254
    v_and_b32 v14, 0xffff0000, v14
    v_and_b32 v15, 0xffff0000, v15
    v_and_b32 v254, 0xffff0000, v254
    v_mul_f32 v250, v250, v248
    v_mul_f32 v252, v252, v248
    v_mul_f32 v251, v251, v248
    v_mul_f32 v14, v14, v249
    v_mul_f32 v15, v15, v249
    v_mul_f32 v254, v254, v249
    v_add_u32 v250, s60, v250
    v_add_u32 v252, s60, v252
    v_perm_b32 v245, v15, v251, s56
    v_perm_b32 v244, v14, v250, s56
    v_perm_b32 v246, v254, v252, s56
    s_mov_b32 s52, 40960
    buffer_store_dwordx4 v[244:247], v3, s[40:43], s52 offen offset:640 sc1
    s_waitcnt lgkmcnt(0)
    s_barrier
    ds_read_b32 v14, v1 offset:20480
    ds_read_b32 v15, v1 offset:45056
    ds_read_b32 v254, v2 offset:20480
    s_waitcnt lgkmcnt(6)
    v_perm_b32 v234, v238, v234, s56
    v_mov_b32_dpp v248, v230 quad_perm:[1,0,3,2] row_mask:0xf bank_mask:0xf
    v_mov_b32_dpp v249, v226 quad_perm:[1,0,3,2] row_mask:0xf bank_mask:0xf
    v_mov_b32_dpp v238, v234 quad_perm:[1,0,3,2] row_mask:0xf bank_mask:0xf
    v_cndmask_b32 v248, v248, v226, s[80:81]
    v_cndmask_b32 v249, v230, v249, s[80:81]
    v_perm_b32 v243, v238, v234, v4
    v_lshlrev_b32 v250, 16, v7
    v_lshlrev_b32 v251, 16, v8
    v_lshlrev_b32 v252, 16, v9
    v_and_b32 v7, 0xffff0000, v7
    v_and_b32 v8, 0xffff0000, v8
    v_and_b32 v9, 0xffff0000, v9
    v_mul_f32 v250, v250, v248
    v_mul_f32 v252, v252, v248
    v_mul_f32 v251, v251, v248
    v_mul_f32 v7, v7, v249
    v_mul_f32 v8, v8, v249
    v_mul_f32 v9, v9, v249
    v_add_u32 v250, s60, v250
    v_add_u32 v252, s60, v252
    v_perm_b32 v241, v8, v251, s56
    v_perm_b32 v240, v7, v250, s56
    v_perm_b32 v242, v9, v252, s56
    s_mov_b32 s52, 40960
    buffer_store_dwordx4 v[240:243], v3, s[40:43], s52 offen offset:1280 sc1
    ds_read_b32 v7, v1 offset:20736
    ds_read_b32 v8, v1 offset:45312
    ds_read_b32 v9, v2 offset:20736
    s_waitcnt lgkmcnt(6)
    v_perm_b32 v235, v239, v235, s56
    v_mov_b32_dpp v248, v231 quad_perm:[1,0,3,2] row_mask:0xf bank_mask:0xf
    v_mov_b32_dpp v249, v227 quad_perm:[1,0,3,2] row_mask:0xf bank_mask:0xf
    v_mov_b32_dpp v239, v235 quad_perm:[1,0,3,2] row_mask:0xf bank_mask:0xf
    v_cndmask_b32 v248, v248, v227, s[80:81]
    v_cndmask_b32 v249, v231, v249, s[80:81]
    v_perm_b32 v247, v239, v235, v4
    v_lshlrev_b32 v250, 16, v10
    v_lshlrev_b32 v251, 16, v12
    v_lshlrev_b32 v252, 16, v13
    v_and_b32 v10, 0xffff0000, v10
    v_and_b32 v12, 0xffff0000, v12
    v_and_b32 v13, 0xffff0000, v13
    v_mul_f32 v250, v250, v248
    v_mul_f32 v252, v252, v248
    v_mul_f32 v251, v251, v248
    v_mul_f32 v10, v10, v249
    v_mul_f32 v12, v12, v249
    v_mul_f32 v13, v13, v249
    v_add_u32 v250, s60, v250
    v_add_u32 v252, s60, v252
    v_perm_b32 v245, v12, v251, s56
    v_perm_b32 v244, v10, v250, s56
    v_perm_b32 v246, v13, v252, s56
    s_mov_b32 s52, 40960
    buffer_store_dwordx4 v[244:247], v3, s[40:43], s52 offen offset:1920 sc1
    ds_read_b32 v10, v1 offset:20992
    ds_read_b32 v12, v1 offset:45568
    ds_read_b32 v13, v2 offset:20992
    s_waitcnt lgkmcnt(6)
    v_perm_b32 v168, v172, v168, s56
    v_mov_b32_dpp v248, v164 quad_perm:[1,0,3,2] row_mask:0xf bank_mask:0xf
    v_mov_b32_dpp v249, v160 quad_perm:[1,0,3,2] row_mask:0xf bank_mask:0xf
    v_mov_b32_dpp v172, v168 quad_perm:[1,0,3,2] row_mask:0xf bank_mask:0xf
    v_cndmask_b32 v248, v248, v160, s[80:81]
    v_cndmask_b32 v249, v164, v249, s[80:81]
    v_perm_b32 v243, v172, v168, v4
    v_lshlrev_b32 v250, 16, v14
    v_lshlrev_b32 v251, 16, v15
    v_lshlrev_b32 v252, 16, v254
    v_and_b32 v14, 0xffff0000, v14
    v_and_b32 v15, 0xffff0000, v15
    v_and_b32 v254, 0xffff0000, v254
    v_mul_f32 v250, v250, v248
    v_mul_f32 v252, v252, v248
    v_mul_f32 v251, v251, v248
    v_mul_f32 v14, v14, v249
    v_mul_f32 v15, v15, v249
    v_mul_f32 v254, v254, v249
    v_add_u32 v250, s60, v250
    v_add_u32 v252, s60, v252
    v_perm_b32 v241, v15, v251, s56
    v_perm_b32 v240, v14, v250, s56
    v_perm_b32 v242, v254, v252, s56
    s_mov_b32 s52, 51200
    buffer_store_dwordx4 v[240:243], v3, s[40:43], s52 offen offset:0 sc1
    ds_read_b32 v14, v1 offset:21248
    ds_read_b32 v15, v1 offset:45824
    ds_read_b32 v254, v2 offset:21248
    s_waitcnt lgkmcnt(6)
    v_perm_b32 v169, v173, v169, s56
    v_mov_b32_dpp v248, v165 quad_perm:[1,0,3,2] row_mask:0xf bank_mask:0xf
    v_mov_b32_dpp v249, v161 quad_perm:[1,0,3,2] row_mask:0xf bank_mask:0xf
    v_mov_b32_dpp v173, v169 quad_perm:[1,0,3,2] row_mask:0xf bank_mask:0xf
    v_cndmask_b32 v248, v248, v161, s[80:81]
    v_cndmask_b32 v249, v165, v249, s[80:81]
    v_perm_b32 v247, v173, v169, v4
    v_lshlrev_b32 v250, 16, v7
    v_lshlrev_b32 v251, 16, v8
    v_lshlrev_b32 v252, 16, v9
    v_and_b32 v7, 0xffff0000, v7
    v_and_b32 v8, 0xffff0000, v8
    v_and_b32 v9, 0xffff0000, v9
    v_mul_f32 v250, v250, v248
    v_mul_f32 v252, v252, v248
    v_mul_f32 v251, v251, v248
    v_mul_f32 v7, v7, v249
    v_mul_f32 v8, v8, v249
    v_mul_f32 v9, v9, v249
    v_add_u32 v250, s60, v250
    v_add_u32 v252, s60, v252
    v_perm_b32 v245, v8, v251, s56
    v_perm_b32 v244, v7, v250, s56
    v_perm_b32 v246, v9, v252, s56
    s_mov_b32 s52, 51200
    buffer_store_dwordx4 v[244:247], v3, s[40:43], s52 offen offset:640 sc1
    s_waitcnt lgkmcnt(3)
    v_perm_b32 v170, v174, v170, s56
    v_mov_b32_dpp v248, v166 quad_perm:[1,0,3,2] row_mask:0xf bank_mask:0xf
    v_mov_b32_dpp v249, v162 quad_perm:[1,0,3,2] row_mask:0xf bank_mask:0xf
    v_mov_b32_dpp v174, v170 quad_perm:[1,0,3,2] row_mask:0xf bank_mask:0xf
    v_cndmask_b32 v248, v248, v162, s[80:81]
    v_cndmask_b32 v249, v166, v249, s[80:81]
    v_perm_b32 v243, v174, v170, v4
    v_lshlrev_b32 v250, 16, v10
    v_lshlrev_b32 v251, 16, v12
    v_lshlrev_b32 v252, 16, v13
    v_and_b32 v10, 0xffff0000, v10
    v_and_b32 v12, 0xffff0000, v12
    v_and_b32 v13, 0xffff0000, v13
    v_mul_f32 v250, v250, v248
    v_mul_f32 v252, v252, v248
    v_mul_f32 v251, v251, v248
    v_mul_f32 v10, v10, v249
    v_mul_f32 v12, v12, v249
    v_mul_f32 v13, v13, v249
    v_add_u32 v250, s60, v250
    v_add_u32 v252, s60, v252
    v_perm_b32 v241, v12, v251, s56
    v_perm_b32 v240, v10, v250, s56
    v_perm_b32 v242, v13, v252, s56
    s_mov_b32 s52, 51200
    buffer_store_dwordx4 v[240:243], v3, s[40:43], s52 offen offset:1280 sc1
    s_waitcnt lgkmcnt(0)
    v_perm_b32 v171, v175, v171, s56
    v_mov_b32_dpp v248, v167 quad_perm:[1,0,3,2] row_mask:0xf bank_mask:0xf
    v_mov_b32_dpp v249, v163 quad_perm:[1,0,3,2] row_mask:0xf bank_mask:0xf
    v_mov_b32_dpp v175, v171 quad_perm:[1,0,3,2] row_mask:0xf bank_mask:0xf
    v_cndmask_b32 v248, v248, v163, s[80:81]
    v_cndmask_b32 v249, v167, v249, s[80:81]
    v_perm_b32 v247, v175, v171, v4
    v_lshlrev_b32 v250, 16, v14
    v_lshlrev_b32 v251, 16, v15
    v_lshlrev_b32 v252, 16, v254
    v_and_b32 v14, 0xffff0000, v14
    v_and_b32 v15, 0xffff0000, v15
    v_and_b32 v254, 0xffff0000, v254
    v_mul_f32 v250, v250, v248
    v_mul_f32 v252, v252, v248
    v_mul_f32 v251, v251, v248
    v_mul_f32 v14, v14, v249
    v_mul_f32 v15, v15, v249
    v_mul_f32 v254, v254, v249
    v_add_u32 v250, s60, v250
    v_add_u32 v252, s60, v252
    v_perm_b32 v245, v15, v251, s56
    v_perm_b32 v244, v14, v250, s56
    v_perm_b32 v246, v254, v252, s56
    s_mov_b32 s52, 51200
    buffer_store_dwordx4 v[244:247], v3, s[40:43], s52 offen offset:1920 sc1
    s_branch K1_GFIN_26
K1_G1_25:
    s_mov_b32 s54, 0xbfb8aa3b
    s_mov_b32 s55, 0xbfb8aa3b
    s_setprio 1
    s_waitcnt lgkmcnt(0)
    s_barrier
    ds_read_b64_tr_b16 v[32:33], v9 offset:0
    ds_read_b64_tr_b16 v[34:35], v9 offset:2048
    ds_read_b64_tr_b16 v[36:37], v10 offset:0
    ds_read_b64_tr_b16 v[38:39], v10 offset:2048
    ds_read_b64_tr_b16 v[40:41], v9 offset:256
    ds_read_b64_tr_b16 v[42:43], v9 offset:2304
    ds_read_b64_tr_b16 v[44:45], v10 offset:256
    ds_read_b64_tr_b16 v[46:47], v10 offset:2304
    ds_read_b64_tr_b16 v[48:49], v9 offset:16384
    ds_read_b64_tr_b16 v[50:51], v9 offset:18432
    ds_read_b64_tr_b16 v[52:53], v10 offset:16384
    ds_read_b64_tr_b16 v[54:55], v10 offset:18432
    s_waitcnt lgkmcnt(6)
    ds_read_b64_tr_b16 v[56:57], v9 offset:16640
    ds_read_b64_tr_b16 v[58:59], v9 offset:18688
    ds_read_b64_tr_b16 v[60:61], v10 offset:16640
    ds_read_b64_tr_b16 v[62:63], v10 offset:18688
    s_waitcnt lgkmcnt(6)
    ds_read_b128 v[128:131], v5 offset:0
    ds_read_b128 v[132:135], v5 offset:8192
    ds_read_b128 v[136:139], v5 offset:16384
    ds_read_b128 v[140:143], v5 offset:24576
    ds_read_b128 v[144:147], v5 offset:32768
    s_waitcnt lgkmcnt(0)
    s_barrier
    v_mfma_f32_16x16x32_bf16 v[160:163], v[128:131], v[32:35], 0
    ds_read_b64_tr_b16 v[64:65], v7 offset:0
    v_mfma_f32_16x16x32_bf16 v[164:167], v[128:131], v[36:39], 0
    ds_read_b64_tr_b16 v[66:67], v7 offset:2048
    v_mfma_f32_16x16x32_bf16 v[168:171], v[128:131], v[40:43], 0
    ds_read_b64_tr_b16 v[68:69], v8 offset:0
    v_mfma_f32_16x16x32_bf16 v[172:175], v[128:131], v[44:47], 0
    ds_read_b128 v[148:151], v5 offset:40960
    v_mfma_f32_16x16x32_bf16 v[176:179], v[132:135], v[32:35], 0
    ds_read_b64_tr_b16 v[70:71], v8 offset:2048
    v_mfma_f32_16x16x32_bf16 v[180:183], v[132:135], v[36:39], 0
    ds_read_b64_tr_b16 v[72:73], v7 offset:256
    v_mfma_f32_16x16x32_bf16 v[184:187], v[132:135], v[40:43], 0
    v_xor_b32 v6, 64, v5
    ds_read_b64_tr_b16 v[74:75], v7 offset:2304
    v_mfma_f32_16x16x32_bf16 v[188:191], v[132:135], v[44:47], 0
    ds_read_b128 v[152:155], v6 offset:0
    v_mfma_f32_16x16x32_bf16 v[192:195], v[136:139], v[32:35], 0
    ds_read_b64_tr_b16 v[76:77], v8 offset:256
    v_mfma_f32_16x16x32_bf16 v[196:199], v[136:139], v[36:39], 0
    ds_read_b64_tr_b16 v[78:79], v8 offset:2304
    v_mfma_f32_16x16x32_bf16 v[200:203], v[136:139], v[40:43], 0
    ds_read_b64_tr_b16 v[80:81], v7 offset:16384
    v_mfma_f32_16x16x32_bf16 v[204:207], v[136:139], v[44:47], 0
    ds_read_b128 v[156:159], v6 offset:8192
    s_waitcnt lgkmcnt(8)
    v_mfma_f32_16x16x32_bf16 v[208:211], v[140:143], v[32:35], 0
    ds_read_b64_tr_b16 v[82:83], v7 offset:18432
    v_mfma_f32_16x16x32_bf16 v[212:215], v[140:143], v[36:39], 0
    ds_read_b64_tr_b16 v[84:85], v8 offset:16384
    v_mfma_f32_16x16x32_bf16 v[216:219], v[140:143], v[40:43], 0
    ds_read_b64_tr_b16 v[86:87], v8 offset:18432
    v_mfma_f32_16x16x32_bf16 v[220:223], v[140:143], v[44:47], 0
    ds_read_b128 v[128:131], v6 offset:16384
    s_waitcnt lgkmcnt(8)
    v_mfma_f32_16x16x32_bf16 v[224:227], v[144:147], v[32:35], 0
    ds_read_b64_tr_b16 v[88:89], v7 offset:16640
    v_mfma_f32_16x16x32_bf16 v[228:231], v[144:147], v[36:39], 0
    ds_read_b64_tr_b16 v[90:91], v7 offset:18688
    v_mfma_f32_16x16x32_bf16 v[232:235], v[144:147], v[40:43], 0
    ds_read_b64_tr_b16 v[92:93], v8 offset:16640
    v_mfma_f32_16x16x32_bf16 v[236:239], v[144:147], v[44:47], 0
    ds_read_b128 v[132:135], v6 offset:24576
    s_waitcnt lgkmcnt(8)
    v_mfma_f32_16x16x32_bf16 v[240:243], v[148:151], v[32:35], 0
    ds_read_b64_tr_b16 v[94:95], v8 offset:18688
    v_mfma_f32_16x16x32_bf16 v[244:247], v[148:151], v[36:39], 0
    v_mfma_f32_16x16x32_bf16 v[248:251], v[148:151], v[40:43], 0
    v_mfma_f32_16x16x32_bf16 v[252:255], v[148:151], v[44:47], 0
    ds_read_b128 v[136:139], v6 offset:32768
    s_waitcnt lgkmcnt(0)
    s_barrier
    v_mfma_f32_16x16x32_bf16 v[160:163], v[152:155], v[48:51], v[160:163]
    ds_read_b64_tr_b16 v[96:97], v7 offset:32768
    v_mfma_f32_16x16x32_bf16 v[164:167], v[152:155], v[52:55], v[164:167]
    ds_read_b64_tr_b16 v[98:99], v7 offset:34816
    v_mfma_f32_16x16x32_bf16 v[168:171], v[152:155], v[56:59], v[168:171]
    ds_read_b64_tr_b16 v[100:101], v8 offset:32768
    v_mfma_f32_16x16x32_bf16 v[172:175], v[152:155], v[60:63], v[172:175]
    ds_read_b128 v[140:143], v6 offset:40960
    v_mfma_f32_16x16x32_bf16 v[176:179], v[156:159], v[48:51], v[176:179]
    ds_read_b64_tr_b16 v[102:103], v8 offset:34816
    v_mfma_f32_16x16x32_bf16 v[180:183], v[156:159], v[52:55], v[180:183]
    ds_read_b64_tr_b16 v[104:105], v7 offset:33024
    v_mfma_f32_16x16x32_bf16 v[184:187], v[156:159], v[56:59], v[184:187]
    v_xor_b32 v6, 128, v5
    ds_read_b64_tr_b16 v[106:107], v7 offset:35072
    v_mfma_f32_16x16x32_bf16 v[188:191], v[156:159], v[60:63], v[188:191]
    ds_read_b128 v[144:147], v6 offset:0
    v_mfma_f32_16x16x32_bf16 v[192:195], v[128:131], v[48:51], v[192:195]
    ds_read_b64_tr_b16 v[108:109], v8 offset:33024
    v_mfma_f32_16x16x32_bf16 v[196:199], v[128:131], v[52:55], v[196:199]
    ds_read_b64_tr_b16 v[110:111], v8 offset:35072
    v_mfma_f32_16x16x32_bf16 v[200:203], v[128:131], v[56:59], v[200:203]
    ds_read_b64_tr_b16 v[112:113], v7 offset:49152
    v_mfma_f32_16x16x32_bf16 v[204:207], v[128:131], v[60:63], v[204:207]
    ds_read_b128 v[148:151], v6 offset:8192
    s_waitcnt lgkmcnt(8)
    v_mfma_f32_16x16x32_bf16 v[208:211], v[132:135], v[48:51], v[208:211]
    ds_read_b64_tr_b16 v[114:115], v7 offset:51200
    v_mfma_f32_16x16x32_bf16 v[212:215], v[132:135], v[52:55], v[212:215]
    ds_read_b64_tr_b16 v[116:117], v8 offset:49152
    v_mfma_f32_16x16x32_bf16 v[216:219], v[132:135], v[56:59], v[216:219]
    ds_read_b64_tr_b16 v[118:119], v8 offset:51200
    v_mfma_f32_16x16x32_bf16 v[220:223], v[132:135], v[60:63], v[220:223]
    ds_read_b128 v[152:155], v6 offset:16384
    s_waitcnt lgkmcnt(8)
    v_mfma_f32_16x16x32_bf16 v[224:227], v[136:139], v[48:51], v[224:227]
    ds_read_b64_tr_b16 v[120:121], v7 offset:49408
    v_mfma_f32_16x16x32_bf16 v[228:231], v[136:139], v[52:55], v[228:231]
    ds_read_b64_tr_b16 v[122:123], v7 offset:51456
    v_mfma_f32_16x16x32_bf16 v[232:235], v[136:139], v[56:59], v[232:235]
    ds_read_b64_tr_b16 v[124:125], v8 offset:49408
    v_mfma_f32_16x16x32_bf16 v[236:239], v[136:139], v[60:63], v[236:239]
    ds_read_b128 v[156:159], v6 offset:24576
    s_waitcnt lgkmcnt(8)
    v_mfma_f32_16x16x32_bf16 v[240:243], v[140:143], v[48:51], v[240:243]
    ds_read_b64_tr_b16 v[126:127], v8 offset:51456
    v_mfma_f32_16x16x32_bf16 v[244:247], v[140:143], v[52:55], v[244:247]
    v_mfma_f32_16x16x32_bf16 v[248:251], v[140:143], v[56:59], v[248:251]
    v_mfma_f32_16x16x32_bf16 v[252:255], v[140:143], v[60:63], v[252:255]
    ds_read_b128 v[128:131], v6 offset:32768
    s_waitcnt lgkmcnt(0)
    s_barrier
    v_mfma_f32_16x16x32_bf16 v[160:163], v[144:147], v[64:67], v[160:163]
    ds_read_b64_tr_b16 v[32:33], v9 offset:0
    v_mfma_f32_16x16x32_bf16 v[164:167], v[144:147], v[68:71], v[164:167]
    ds_read_b64_tr_b16 v[34:35], v9 offset:2048
    v_mfma_f32_16x16x32_bf16 v[168:171], v[144:147], v[72:75], v[168:171]
    ds_read_b64_tr_b16 v[36:37], v10 offset:0
    v_mfma_f32_16x16x32_bf16 v[172:175], v[144:147], v[76:79], v[172:175]
    ds_read_b128 v[132:135], v6 offset:40960
    v_mfma_f32_16x16x32_bf16 v[176:179], v[148:151], v[64:67], v[176:179]
    ds_read_b64_tr_b16 v[38:39], v10 offset:2048
    v_mfma_f32_16x16x32_bf16 v[180:183], v[148:151], v[68:71], v[180:183]
    ds_read_b64_tr_b16 v[40:41], v9 offset:256
    v_mfma_f32_16x16x32_bf16 v[184:187], v[148:151], v[72:75], v[184:187]
    v_xor_b32 v6, 192, v5
    ds_read_b64_tr_b16 v[42:43], v9 offset:2304
    v_mfma_f32_16x16x32_bf16 v[188:191], v[148:151], v[76:79], v[188:191]
    ds_read_b128 v[136:139], v6 offset:0
    v_mfma_f32_16x16x32_bf16 v[192:195], v[152:155], v[64:67], v[192:195]
    ds_read_b64_tr_b16 v[44:45], v10 offset:256
    v_mfma_f32_16x16x32_bf16 v[196:199], v[152:155], v[68:71], v[196:199]
    ds_read_b64_tr_b16 v[46:47], v10 offset:2304
    v_mfma_f32_16x16x32_bf16 v[200:203], v[152:155], v[72:75], v[200:203]
    ds_read_b64_tr_b16 v[48:49], v9 offset:16384
    v_mfma_f32_16x16x32_bf16 v[204:207], v[152:155], v[76:79], v[204:207]
    ds_read_b128 v[140:143], v6 offset:8192
    s_waitcnt lgkmcnt(8)
    v_mfma_f32_16x16x32_bf16 v[208:211], v[156:159], v[64:67], v[208:211]
    ds_read_b64_tr_b16 v[50:51], v9 offset:18432
    v_mfma_f32_16x16x32_bf16 v[212:215], v[156:159], v[68:71], v[212:215]
    ds_read_b64_tr_b16 v[52:53], v10 offset:16384
    v_mfma_f32_16x16x32_bf16 v[216:219], v[156:159], v[72:75], v[216:219]
    ds_read_b64_tr_b16 v[54:55], v10 offset:18432
    v_mfma_f32_16x16x32_bf16 v[220:223], v[156:159], v[76:79], v[220:223]
    ds_read_b128 v[144:147], v6 offset:16384
    s_waitcnt lgkmcnt(8)
    v_mfma_f32_16x16x32_bf16 v[224:227], v[128:131], v[64:67], v[224:227]
    ds_read_b64_tr_b16 v[56:57], v9 offset:16640
    v_mfma_f32_16x16x32_bf16 v[228:231], v[128:131], v[68:71], v[228:231]
    ds_read_b64_tr_b16 v[58:59], v9 offset:18688
    v_mfma_f32_16x16x32_bf16 v[232:235], v[128:131], v[72:75], v[232:235]
    ds_read_b64_tr_b16 v[60:61], v10 offset:16640
    v_mfma_f32_16x16x32_bf16 v[236:239], v[128:131], v[76:79], v[236:239]
    ds_read_b128 v[148:151], v6 offset:24576
    s_waitcnt lgkmcnt(8)
    v_mfma_f32_16x16x32_bf16 v[240:243], v[132:135], v[64:67], v[240:243]
    ds_read_b64_tr_b16 v[62:63], v10 offset:18688
    v_mfma_f32_16x16x32_bf16 v[244:247], v[132:135], v[68:71], v[244:247]
    v_mfma_f32_16x16x32_bf16 v[248:251], v[132:135], v[72:75], v[248:251]
    v_mfma_f32_16x16x32_bf16 v[252:255], v[132:135], v[76:79], v[252:255]
    ds_read_b128 v[152:155], v6 offset:32768
    s_waitcnt lgkmcnt(0)
    s_barrier
    v_mfma_f32_16x16x32_bf16 v[160:163], v[136:139], v[80:83], v[160:163]
    v_mfma_f32_16x16x32_bf16 v[164:167], v[136:139], v[84:87], v[164:167]
    v_mfma_f32_16x16x32_bf16 v[168:171], v[136:139], v[88:91], v[168:171]
    ds_read_b128 v[156:159], v6 offset:40960
    v_mfma_f32_16x16x32_bf16 v[172:175], v[136:139], v[92:95], v[172:175]
    v_mfma_f32_16x16x32_bf16 v[176:179], v[140:143], v[80:83], v[176:179]
    v_mfma_f32_16x16x32_bf16 v[180:183], v[140:143], v[84:87], v[180:183]
    v_xor_b32 v6, 256, v5
    v_mfma_f32_16x16x32_bf16 v[184:187], v[140:143], v[88:91], v[184:187]
    ds_read_b128 v[128:131], v6 offset:0
    v_mfma_f32_16x16x32_bf16 v[188:191], v[140:143], v[92:95], v[188:191]
    v_mfma_f32_16x16x32_bf16 v[192:195], v[144:147], v[80:83], v[192:195]
    v_mfma_f32_16x16x32_bf16 v[196:199], v[144:147], v[84:87], v[196:199]
    v_mfma_f32_16x16x32_bf16 v[200:203], v[144:147], v[88:91], v[200:203]
    ds_read_b128 v[132:135], v6 offset:8192
    v_mfma_f32_16x16x32_bf16 v[204:207], v[144:147], v[92:95], v[204:207]
    v_mfma_f32_16x16x32_bf16 v[208:211], v[148:151], v[80:83], v[208:211]
    v_mfma_f32_16x16x32_bf16 v[212:215], v[148:151], v[84:87], v[212:215]
    v_mfma_f32_16x16x32_bf16 v[216:219], v[148:151], v[88:91], v[216:219]
    ds_read_b128 v[136:139], v6 offset:16384
    v_mfma_f32_16x16x32_bf16 v[220:223], v[148:151], v[92:95], v[220:223]
    v_mfma_f32_16x16x32_bf16 v[224:227], v[152:155], v[80:83], v[224:227]
    v_mfma_f32_16x16x32_bf16 v[228:231], v[152:155], v[84:87], v[228:231]
    v_mfma_f32_16x16x32_bf16 v[232:235], v[152:155], v[88:91], v[232:235]
    ds_read_b128 v[140:143], v6 offset:24576
    v_mfma_f32_16x16x32_bf16 v[236:239], v[152:155], v[92:95], v[236:239]
    s_waitcnt lgkmcnt(4)
    v_mfma_f32_16x16x32_bf16 v[240:243], v[156:159], v[80:83], v[240:243]
    v_mfma_f32_16x16x32_bf16 v[244:247], v[156:159], v[84:87], v[244:247]
    v_mfma_f32_16x16x32_bf16 v[248:251], v[156:159], v[88:91], v[248:251]
    ds_read_b128 v[144:147], v6 offset:32768
    v_mfma_f32_16x16x32_bf16 v[252:255], v[156:159], v[92:95], v[252:255]
    s_barrier
    s_waitcnt lgkmcnt(4)
    v_mfma_f32_16x16x32_bf16 v[160:163], v[128:131], v[96:99], v[160:163]
    v_mfma_f32_16x16x32_bf16 v[164:167], v[128:131], v[100:103], v[164:167]
    v_mfma_f32_16x16x32_bf16 v[168:171], v[128:131], v[104:107], v[168:171]
    ds_read_b128 v[148:151], v6 offset:40960
    v_mfma_f32_16x16x32_bf16 v[172:175], v[128:131], v[108:111], v[172:175]
    s_waitcnt lgkmcnt(4)
    v_mfma_f32_16x16x32_bf16 v[176:179], v[132:135], v[96:99], v[176:179]
    v_mfma_f32_16x16x32_bf16 v[180:183], v[132:135], v[100:103], v[180:183]
    v_xor_b32 v6, 320, v5
    v_mfma_f32_16x16x32_bf16 v[184:187], v[132:135], v[104:107], v[184:187]
    ds_read_b128 v[152:155], v6 offset:0
    v_mfma_f32_16x16x32_bf16 v[188:191], v[132:135], v[108:111], v[188:191]
    s_waitcnt lgkmcnt(4)
    v_mfma_f32_16x16x32_bf16 v[192:195], v[136:139], v[96:99], v[192:195]
    v_mfma_f32_16x16x32_bf16 v[196:199], v[136:139], v[100:103], v[196:199]
    v_mfma_f32_16x16x32_bf16 v[200:203], v[136:139], v[104:107], v[200:203]
    ds_read_b128 v[156:159], v6 offset:8192
    v_mfma_f32_16x16x32_bf16 v[204:207], v[136:139], v[108:111], v[204:207]
    s_waitcnt lgkmcnt(4)
    v_mfma_f32_16x16x32_bf16 v[208:211], v[140:143], v[96:99], v[208:211]
    v_mfma_f32_16x16x32_bf16 v[212:215], v[140:143], v[100:103], v[212:215]
    v_mfma_f32_16x16x32_bf16 v[216:219], v[140:143], v[104:107], v[216:219]
    ds_read_b128 v[128:131], v6 offset:16384
    v_mfma_f32_16x16x32_bf16 v[220:223], v[140:143], v[108:111], v[220:223]
    s_waitcnt lgkmcnt(4)
    v_mfma_f32_16x16x32_bf16 v[224:227], v[144:147], v[96:99], v[224:227]
    v_mfma_f32_16x16x32_bf16 v[228:231], v[144:147], v[100:103], v[228:231]
    v_mfma_f32_16x16x32_bf16 v[232:235], v[144:147], v[104:107], v[232:235]
    ds_read_b128 v[132:135], v6 offset:24576
    v_mfma_f32_16x16x32_bf16 v[236:239], v[144:147], v[108:111], v[236:239]
    s_waitcnt lgkmcnt(4)
    v_mfma_f32_16x16x32_bf16 v[240:243], v[148:151], v[96:99], v[240:243]
    v_mfma_f32_16x16x32_bf16 v[244:247], v[148:151], v[100:103], v[244:247]
    v_mfma_f32_16x16x32_bf16 v[248:251], v[148:151], v[104:107], v[248:251]
    ds_read_b128 v[136:139], v6 offset:32768
    v_mfma_f32_16x16x32_bf16 v[252:255], v[148:151], v[108:111], v[252:255]
    s_barrier
    s_waitcnt lgkmcnt(4)
    v_mfma_f32_16x16x32_bf16 v[160:163], v[152:155], v[112:115], v[160:163]
    v_mfma_f32_16x16x32_bf16 v[164:167], v[152:155], v[116:119], v[164:167]
    v_mfma_f32_16x16x32_bf16 v[168:171], v[152:155], v[120:123], v[168:171]
    ds_read_b128 v[140:143], v6 offset:40960
    v_mfma_f32_16x16x32_bf16 v[172:175], v[152:155], v[124:127], v[172:175]
    s_waitcnt lgkmcnt(4)
    v_mfma_f32_16x16x32_bf16 v[176:179], v[156:159], v[112:115], v[176:179]
    v_mfma_f32_16x16x32_bf16 v[180:183], v[156:159], v[116:119], v[180:183]
    v_xor_b32 v6, 384, v5
    v_mfma_f32_16x16x32_bf16 v[184:187], v[156:159], v[120:123], v[184:187]
    ds_read_b128 v[144:147], v6 offset:0
    v_mfma_f32_16x16x32_bf16 v[188:191], v[156:159], v[124:127], v[188:191]
    s_waitcnt lgkmcnt(4)
    v_mfma_f32_16x16x32_bf16 v[192:195], v[128:131], v[112:115], v[192:195]
    v_mfma_f32_16x16x32_bf16 v[196:199], v[128:131], v[116:119], v[196:199]
    v_mfma_f32_16x16x32_bf16 v[200:203], v[128:131], v[120:123], v[200:203]
    ds_read_b128 v[148:151], v6 offset:8192
    v_mfma_f32_16x16x32_bf16 v[204:207], v[128:131], v[124:127], v[204:207]
    s_waitcnt lgkmcnt(4)
    v_mfma_f32_16x16x32_bf16 v[208:211], v[132:135], v[112:115], v[208:211]
    v_mfma_f32_16x16x32_bf16 v[212:215], v[132:135], v[116:119], v[212:215]
    v_mfma_f32_16x16x32_bf16 v[216:219], v[132:135], v[120:123], v[216:219]
    ds_read_b128 v[152:155], v6 offset:16384
    v_mfma_f32_16x16x32_bf16 v[220:223], v[132:135], v[124:127], v[220:223]
    s_waitcnt lgkmcnt(4)
    v_mfma_f32_16x16x32_bf16 v[224:227], v[136:139], v[112:115], v[224:227]
    v_mfma_f32_16x16x32_bf16 v[228:231], v[136:139], v[116:119], v[228:231]
    v_mfma_f32_16x16x32_bf16 v[232:235], v[136:139], v[120:123], v[232:235]
    ds_read_b128 v[156:159], v6 offset:24576
    v_mfma_f32_16x16x32_bf16 v[236:239], v[136:139], v[124:127], v[236:239]
    s_waitcnt lgkmcnt(4)
    v_mfma_f32_16x16x32_bf16 v[240:243], v[140:143], v[112:115], v[240:243]
    v_mfma_f32_16x16x32_bf16 v[244:247], v[140:143], v[116:119], v[244:247]
    v_mfma_f32_16x16x32_bf16 v[248:251], v[140:143], v[120:123], v[248:251]
    ds_read_b128 v[128:131], v6 offset:32768
    v_mfma_f32_16x16x32_bf16 v[252:255], v[140:143], v[124:127], v[252:255]
    s_barrier
    s_waitcnt lgkmcnt(4)
    v_mfma_f32_16x16x32_bf16 v[160:163], v[144:147], v[32:35], v[160:163]
    v_mfma_f32_16x16x32_bf16 v[164:167], v[144:147], v[36:39], v[164:167]
    v_mfma_f32_16x16x32_bf16 v[168:171], v[144:147], v[40:43], v[168:171]
    ds_read_b128 v[132:135], v6 offset:40960
    v_mfma_f32_16x16x32_bf16 v[172:175], v[144:147], v[44:47], v[172:175]
    s_waitcnt lgkmcnt(4)
    v_mfma_f32_16x16x32_bf16 v[176:179], v[148:151], v[32:35], v[176:179]
    v_mfma_f32_16x16x32_bf16 v[180:183], v[148:151], v[36:39], v[180:183]
    v_xor_b32 v6, 448, v5
    v_mfma_f32_16x16x32_bf16 v[184:187], v[148:151], v[40:43], v[184:187]
    ds_read_b128 v[136:139], v6 offset:0
    v_mfma_f32_16x16x32_bf16 v[188:191], v[148:151], v[44:47], v[188:191]
    s_waitcnt lgkmcnt(4)
    v_mfma_f32_16x16x32_bf16 v[192:195], v[152:155], v[32:35], v[192:195]
    v_mfma_f32_16x16x32_bf16 v[196:199], v[152:155], v[36:39], v[196:199]
    v_mfma_f32_16x16x32_bf16 v[200:203], v[152:155], v[40:43], v[200:203]
    ds_read_b128 v[140:143], v6 offset:8192
    v_mfma_f32_16x16x32_bf16 v[204:207], v[152:155], v[44:47], v[204:207]
    s_waitcnt lgkmcnt(4)
    v_mfma_f32_16x16x32_bf16 v[208:211], v[156:159], v[32:35], v[208:211]
    v_mfma_f32_16x16x32_bf16 v[212:215], v[156:159], v[36:39], v[212:215]
    v_mfma_f32_16x16x32_bf16 v[216:219], v[156:159], v[40:43], v[216:219]
    ds_read_b128 v[144:147], v6 offset:16384
    v_mfma_f32_16x16x32_bf16 v[220:223], v[156:159], v[44:47], v[220:223]
    s_waitcnt lgkmcnt(4)
    v_mfma_f32_16x16x32_bf16 v[224:227], v[128:131], v[32:35], v[224:227]
    v_mfma_f32_16x16x32_bf16 v[228:231], v[128:131], v[36:39], v[228:231]
    v_mfma_f32_16x16x32_bf16 v[232:235], v[128:131], v[40:43], v[232:235]
    ds_read_b128 v[148:151], v6 offset:24576
    v_mfma_f32_16x16x32_bf16 v[236:239], v[128:131], v[44:47], v[236:239]
    s_waitcnt lgkmcnt(4)
    v_mfma_f32_16x16x32_bf16 v[240:243], v[132:135], v[32:35], v[240:243]
    v_mfma_f32_16x16x32_bf16 v[244:247], v[132:135], v[36:39], v[244:247]
    v_mfma_f32_16x16x32_bf16 v[248:251], v[132:135], v[40:43], v[248:251]
    ds_read_b128 v[152:155], v6 offset:32768
    v_mfma_f32_16x16x32_bf16 v[252:255], v[132:135], v[44:47], v[252:255]
    s_barrier
    s_waitcnt lgkmcnt(4)
    v_mfma_f32_16x16x32_bf16 v[160:163], v[136:139], v[48:51], v[160:163]
    v_mfma_f32_16x16x32_bf16 v[164:167], v[136:139], v[52:55], v[164:167]
    v_mfma_f32_16x16x32_bf16 v[168:171], v[136:139], v[56:59], v[168:171]
    ds_read_b128 v[156:159], v6 offset:40960
    v_mfma_f32_16x16x32_bf16 v[172:175], v[136:139], v[60:63], v[172:175]
    s_waitcnt lgkmcnt(4)
    v_mfma_f32_16x16x32_bf16 v[176:179], v[140:143], v[48:51], v[176:179]
    v_mfma_f32_16x16x32_bf16 v[180:183], v[140:143], v[52:55], v[180:183]
    v_mfma_f32_16x16x32_bf16 v[184:187], v[140:143], v[56:59], v[184:187]
    v_mfma_f32_16x16x32_bf16 v[188:191], v[140:143], v[60:63], v[188:191]
    s_waitcnt lgkmcnt(3)
    v_mfma_f32_16x16x32_bf16 v[192:195], v[144:147], v[48:51], v[192:195]
    v_mfma_f32_16x16x32_bf16 v[196:199], v[144:147], v[52:55], v[196:199]
    v_mfma_f32_16x16x32_bf16 v[200:203], v[144:147], v[56:59], v[200:203]
    v_mfma_f32_16x16x32_bf16 v[204:207], v[144:147], v[60:63], v[204:207]
    s_waitcnt lgkmcnt(2)
    v_mfma_f32_16x16x32_bf16 v[208:211], v[148:151], v[48:51], v[208:211]
    v_mfma_f32_16x16x32_bf16 v[212:215], v[148:151], v[52:55], v[212:215]
    v_mfma_f32_16x16x32_bf16 v[216:219], v[148:151], v[56:59], v[216:219]
    v_mfma_f32_16x16x32_bf16 v[220:223], v[148:151], v[60:63], v[220:223]
    s_waitcnt lgkmcnt(1)
    v_mfma_f32_16x16x32_bf16 v[224:227], v[152:155], v[48:51], v[224:227]
    v_mfma_f32_16x16x32_bf16 v[228:231], v[152:155], v[52:55], v[228:231]
    v_mfma_f32_16x16x32_bf16 v[232:235], v[152:155], v[56:59], v[232:235]
    v_mfma_f32_16x16x32_bf16 v[236:239], v[152:155], v[60:63], v[236:239]
    s_waitcnt lgkmcnt(0)
    v_mfma_f32_16x16x32_bf16 v[240:243], v[156:159], v[48:51], v[240:243]
    v_mfma_f32_16x16x32_bf16 v[244:247], v[156:159], v[52:55], v[244:247]
    v_mfma_f32_16x16x32_bf16 v[248:251], v[156:159], v[56:59], v[248:251]
    v_mfma_f32_16x16x32_bf16 v[252:255], v[156:159], v[60:63], v[252:255]
    s_waitcnt lgkmcnt(0)
    s_barrier
    v_pk_mul_f32 v[16:17], v[160:161], s[54:55]
    v_pk_mul_f32 v[18:19], v[162:163], s[54:55]
    v_pk_mul_f32 v[20:21], v[164:165], s[54:55]
    v_pk_mul_f32 v[22:23], v[166:167], s[54:55]
    v_exp_f32 v16, v16
    v_exp_f32 v17, v17
    v_exp_f32 v18, v18
    v_exp_f32 v19, v19
    v_exp_f32 v20, v20
    v_exp_f32 v21, v21
    v_exp_f32 v22, v22
    v_exp_f32 v23, v23
    v_pk_add_f32 v[16:17], v[16:17], 1.0 op_sel_hi:[1,0]
    v_pk_add_f32 v[18:19], v[18:19], 1.0 op_sel_hi:[1,0]
    v_pk_add_f32 v[20:21], v[20:21], 1.0 op_sel_hi:[1,0]
    v_pk_add_f32 v[22:23], v[22:23], 1.0 op_sel_hi:[1,0]
    v_rcp_f32 v16, v16
    v_rcp_f32 v17, v17
    v_rcp_f32 v18, v18
    v_rcp_f32 v19, v19
    v_rcp_f32 v20, v20
    v_rcp_f32 v21, v21
    v_rcp_f32 v22, v22
    v_rcp_f32 v23, v23
    v_pk_mul_f32 v[160:161], v[160:161], v[16:17]
    v_pk_mul_f32 v[162:163], v[162:163], v[18:19]
    v_pk_mul_f32 v[164:165], v[164:165], v[20:21]
    v_pk_mul_f32 v[166:167], v[166:167], v[22:23]
    v_cvt_pk_bf16_f32 v160, v160, v164
    v_cvt_pk_bf16_f32 v161, v161, v165
    v_cvt_pk_bf16_f32 v162, v162, v166
    v_cvt_pk_bf16_f32 v163, v163, v167
    v_pk_mul_f32 v[16:17], v[168:169], s[54:55]
    v_pk_mul_f32 v[18:19], v[170:171], s[54:55]
    v_pk_mul_f32 v[20:21], v[172:173], s[54:55]
    v_pk_mul_f32 v[22:23], v[174:175], s[54:55]
    v_exp_f32 v16, v16
    v_exp_f32 v17, v17
    v_exp_f32 v18, v18
    v_exp_f32 v19, v19
    v_exp_f32 v20, v20
    v_exp_f32 v21, v21
    v_exp_f32 v22, v22
    v_exp_f32 v23, v23
    v_pk_add_f32 v[16:17], v[16:17], 1.0 op_sel_hi:[1,0]
    v_pk_add_f32 v[18:19], v[18:19], 1.0 op_sel_hi:[1,0]
    v_pk_add_f32 v[20:21], v[20:21], 1.0 op_sel_hi:[1,0]
    v_pk_add_f32 v[22:23], v[22:23], 1.0 op_sel_hi:[1,0]
    v_rcp_f32 v16, v16
    v_rcp_f32 v17, v17
    v_rcp_f32 v18, v18
    v_rcp_f32 v19, v19
    v_rcp_f32 v20, v20
    v_rcp_f32 v21, v21
    v_rcp_f32 v22, v22
    v_rcp_f32 v23, v23
    v_pk_mul_f32 v[168:169], v[168:169], v[16:17]
    v_pk_mul_f32 v[170:171], v[170:171], v[18:19]
    v_pk_mul_f32 v[172:173], v[172:173], v[20:21]
    v_pk_mul_f32 v[174:175], v[174:175], v[22:23]
    v_cvt_pk_bf16_f32 v168, v168, v172
    v_cvt_pk_bf16_f32 v169, v169, v173
    v_cvt_pk_bf16_f32 v170, v170, v174
    v_cvt_pk_bf16_f32 v171, v171, v175
    ds_write2st64_b32 v12, v160, v168 offset0:0 offset1:1
    ds_write2st64_b32 v13, v161, v169 offset0:2 offset1:3
    ds_write2st64_b32 v14, v162, v170 offset0:4 offset1:5
    ds_write2st64_b32 v15, v163, v171 offset0:6 offset1:7
    s_waitcnt lgkmcnt(0)
    s_barrier
    v_mul_f32 v16, s54, v176
    v_mul_f32 v17, s54, v177
    v_mul_f32 v18, s54, v178
    v_mul_f32 v19, s54, v179
    v_mul_f32 v20, s54, v180
    v_mul_f32 v21, s54, v181
    v_mul_f32 v22, s54, v182
    v_mul_f32 v23, s54, v183
    v_exp_f32 v16, v16
    v_exp_f32 v17, v17
    v_exp_f32 v18, v18
    v_exp_f32 v19, v19
    v_exp_f32 v20, v20
    v_exp_f32 v21, v21
    v_exp_f32 v22, v22
    v_exp_f32 v23, v23
    v_add_f32 v16, 1.0, v16
    v_add_f32 v17, 1.0, v17
    v_add_f32 v18, 1.0, v18
    v_add_f32 v19, 1.0, v19
    v_add_f32 v20, 1.0, v20
    v_add_f32 v21, 1.0, v21
    v_add_f32 v22, 1.0, v22
    v_add_f32 v23, 1.0, v23
    v_rcp_f32 v16, v16
    v_rcp_f32 v17, v17
    v_rcp_f32 v18, v18
    v_rcp_f32 v19, v19
    v_rcp_f32 v20, v20
    v_rcp_f32 v21, v21
    v_rcp_f32 v22, v22
    v_rcp_f32 v23, v23
    v_mul_f32 v176, v176, v16
    v_mul_f32 v177, v177, v17
    v_mul_f32 v178, v178, v18
    v_mul_f32 v179, v179, v19
    v_mul_f32 v180, v180, v20
    v_mul_f32 v181, v181, v21
    v_mul_f32 v182, v182, v22
    v_mul_f32 v183, v183, v23
    v_cvt_pk_bf16_f32 v176, v176, v180
    v_cvt_pk_bf16_f32 v177, v177, v181
    v_cvt_pk_bf16_f32 v178, v178, v182
    v_cvt_pk_bf16_f32 v179, v179, v183
    v_mul_f32 v16, s54, v184
    v_mul_f32 v17, s54, v185
    v_mul_f32 v18, s54, v186
    v_mul_f32 v19, s54, v187
    v_mul_f32 v20, s54, v188
    v_mul_f32 v21, s54, v189
    v_mul_f32 v22, s54, v190
    v_mul_f32 v23, s54, v191
    v_exp_f32 v16, v16
    v_exp_f32 v17, v17
    v_exp_f32 v18, v18
    v_exp_f32 v19, v19
    v_exp_f32 v20, v20
    v_exp_f32 v21, v21
    v_exp_f32 v22, v22
    v_exp_f32 v23, v23
    v_add_f32 v16, 1.0, v16
    v_add_f32 v17, 1.0, v17
    v_add_f32 v18, 1.0, v18
    v_add_f32 v19, 1.0, v19
    v_add_f32 v20, 1.0, v20
    v_add_f32 v21, 1.0, v21
    v_add_f32 v22, 1.0, v22
    v_add_f32 v23, 1.0, v23
    v_rcp_f32 v16, v16
    v_rcp_f32 v17, v17
    v_rcp_f32 v18, v18
    v_rcp_f32 v19, v19
    v_rcp_f32 v20, v20
    v_rcp_f32 v21, v21
    v_rcp_f32 v22, v22
    v_rcp_f32 v23, v23
    v_mul_f32 v184, v184, v16
    v_mul_f32 v185, v185, v17
    v_mul_f32 v186, v186, v18
    v_mul_f32 v187, v187, v19
    v_mul_f32 v188, v188, v20
    v_mul_f32 v189, v189, v21
    v_mul_f32 v190, v190, v22
    v_mul_f32 v191, v191, v23
    v_cvt_pk_bf16_f32 v184, v184, v188
    v_cvt_pk_bf16_f32 v185, v185, v189
    v_cvt_pk_bf16_f32 v186, v186, v190
    v_cvt_pk_bf16_f32 v187, v187, v191
    ds_write2st64_b32 v12, v176, v184 offset0:32 offset1:33
    ds_write2st64_b32 v13, v177, v185 offset0:34 offset1:35
    ds_write2st64_b32 v14, v178, v186 offset0:36 offset1:37
    ds_write2st64_b32 v15, v179, v187 offset0:38 offset1:39
    s_waitcnt lgkmcnt(0)
    s_barrier
    v_mul_f32 v16, s54, v192
    v_mul_f32 v17, s54, v193
    v_mul_f32 v18, s54, v194
    v_mul_f32 v19, s54, v195
    v_mul_f32 v20, s54, v196
    v_mul_f32 v21, s54, v197
    v_mul_f32 v22, s54, v198
    v_mul_f32 v23, s54, v199
    v_exp_f32 v16, v16
    v_exp_f32 v17, v17
    v_exp_f32 v18, v18
    v_exp_f32 v19, v19
    v_exp_f32 v20, v20
    v_exp_f32 v21, v21
    v_exp_f32 v22, v22
    v_exp_f32 v23, v23
    v_add_f32 v16, 1.0, v16
    v_add_f32 v17, 1.0, v17
    v_add_f32 v18, 1.0, v18
    v_add_f32 v19, 1.0, v19
    v_add_f32 v20, 1.0, v20
    v_add_f32 v21, 1.0, v21
    v_add_f32 v22, 1.0, v22
    v_add_f32 v23, 1.0, v23
    v_rcp_f32 v16, v16
    v_rcp_f32 v17, v17
    v_rcp_f32 v18, v18
    v_rcp_f32 v19, v19
    v_rcp_f32 v20, v20
    v_rcp_f32 v21, v21
    v_rcp_f32 v22, v22
    v_rcp_f32 v23, v23
    v_mul_f32 v192, v192, v16
    v_mul_f32 v193, v193, v17
    v_mul_f32 v194, v194, v18
    v_mul_f32 v195, v195, v19
    v_mul_f32 v196, v196, v20
    v_mul_f32 v197, v197, v21
    v_mul_f32 v198, v198, v22
    v_mul_f32 v199, v199, v23
    v_cvt_pk_bf16_f32 v192, v192, v196
    v_cvt_pk_bf16_f32 v193, v193, v197
    v_cvt_pk_bf16_f32 v194, v194, v198
    v_cvt_pk_bf16_f32 v195, v195, v199
    v_mul_f32 v16, s54, v200
    v_mul_f32 v17, s54, v201
    v_mul_f32 v18, s54, v202
    v_mul_f32 v19, s54, v203
    v_mul_f32 v20, s54, v204
    v_mul_f32 v21, s54, v205
    v_mul_f32 v22, s54, v206
    v_mul_f32 v23, s54, v207
    v_exp_f32 v16, v16
    v_exp_f32 v17, v17
    v_exp_f32 v18, v18
    v_exp_f32 v19, v19
    v_exp_f32 v20, v20
    v_exp_f32 v21, v21
    v_exp_f32 v22, v22
    v_exp_f32 v23, v23
    v_add_f32 v16, 1.0, v16
    v_add_f32 v17, 1.0, v17
    v_add_f32 v18, 1.0, v18
    v_add_f32 v19, 1.0, v19
    v_add_f32 v20, 1.0, v20
    v_add_f32 v21, 1.0, v21
    v_add_f32 v22, 1.0, v22
    v_add_f32 v23, 1.0, v23
    v_rcp_f32 v16, v16
    v_rcp_f32 v17, v17
    v_rcp_f32 v18, v18
    v_rcp_f32 v19, v19
    v_rcp_f32 v20, v20
    v_rcp_f32 v21, v21
    v_rcp_f32 v22, v22
    v_rcp_f32 v23, v23
    v_mul_f32 v200, v200, v16
    v_mul_f32 v201, v201, v17
    v_mul_f32 v202, v202, v18
    v_mul_f32 v203, v203, v19
    v_mul_f32 v204, v204, v20
    v_mul_f32 v205, v205, v21
    v_mul_f32 v206, v206, v22
    v_mul_f32 v207, v207, v23
    v_cvt_pk_bf16_f32 v200, v200, v204
    v_cvt_pk_bf16_f32 v201, v201, v205
    v_cvt_pk_bf16_f32 v202, v202, v206
    v_cvt_pk_bf16_f32 v203, v203, v207
    ds_write2st64_b32 v12, v192, v200 offset0:64 offset1:65
    ds_write2st64_b32 v13, v193, v201 offset0:66 offset1:67
    ds_write2st64_b32 v14, v194, v202 offset0:68 offset1:69
    ds_write2st64_b32 v15, v195, v203 offset0:70 offset1:71
    s_waitcnt lgkmcnt(0)
    s_barrier
    v_mul_f32 v16, s54, v208
    v_mul_f32 v17, s54, v209
    v_mul_f32 v18, s54, v210
    v_mul_f32 v19, s54, v211
    v_mul_f32 v20, s54, v212
    v_mul_f32 v21, s54, v213
    v_mul_f32 v22, s54, v214
    v_mul_f32 v23, s54, v215
    v_exp_f32 v16, v16
    v_exp_f32 v17, v17
    v_exp_f32 v18, v18
    v_exp_f32 v19, v19
    v_exp_f32 v20, v20
    v_exp_f32 v21, v21
    v_exp_f32 v22, v22
    v_exp_f32 v23, v23
    v_add_f32 v16, 1.0, v16
    v_add_f32 v17, 1.0, v17
    v_add_f32 v18, 1.0, v18
    v_add_f32 v19, 1.0, v19
    v_add_f32 v20, 1.0, v20
    v_add_f32 v21, 1.0, v21
    v_add_f32 v22, 1.0, v22
    v_add_f32 v23, 1.0, v23
    v_rcp_f32 v16, v16
    v_rcp_f32 v17, v17
    v_rcp_f32 v18, v18
    v_rcp_f32 v19, v19
    v_rcp_f32 v20, v20
    v_rcp_f32 v21, v21
    v_rcp_f32 v22, v22
    v_rcp_f32 v23, v23
    v_mul_f32 v208, v208, v16
    v_mul_f32 v209, v209, v17
    v_mul_f32 v210, v210, v18
    v_mul_f32 v211, v211, v19
    v_mul_f32 v212, v212, v20
    v_mul_f32 v213, v213, v21
    v_mul_f32 v214, v214, v22
    v_mul_f32 v215, v215, v23
    v_cvt_pk_bf16_f32 v208, v208, v212
    v_cvt_pk_bf16_f32 v209, v209, v213
    v_cvt_pk_bf16_f32 v210, v210, v214
    v_cvt_pk_bf16_f32 v211, v211, v215
    v_mul_f32 v16, s54, v216
    v_mul_f32 v17, s54, v217
    v_mul_f32 v18, s54, v218
    v_mul_f32 v19, s54, v219
    v_mul_f32 v20, s54, v220
    v_mul_f32 v21, s54, v221
    v_mul_f32 v22, s54, v222
    v_mul_f32 v23, s54, v223
    v_exp_f32 v16, v16
    v_exp_f32 v17, v17
    v_exp_f32 v18, v18
    v_exp_f32 v19, v19
    v_exp_f32 v20, v20
    v_exp_f32 v21, v21
    v_exp_f32 v22, v22
    v_exp_f32 v23, v23
    v_add_f32 v16, 1.0, v16
    v_add_f32 v17, 1.0, v17
    v_add_f32 v18, 1.0, v18
    v_add_f32 v19, 1.0, v19
    v_add_f32 v20, 1.0, v20
    v_add_f32 v21, 1.0, v21
    v_add_f32 v22, 1.0, v22
    v_add_f32 v23, 1.0, v23
    v_rcp_f32 v16, v16
    v_rcp_f32 v17, v17
    v_rcp_f32 v18, v18
    v_rcp_f32 v19, v19
    v_rcp_f32 v20, v20
    v_rcp_f32 v21, v21
    v_rcp_f32 v22, v22
    v_rcp_f32 v23, v23
    v_mul_f32 v216, v216, v16
    v_mul_f32 v217, v217, v17
    v_mul_f32 v218, v218, v18
    v_mul_f32 v219, v219, v19
    v_mul_f32 v220, v220, v20
    v_mul_f32 v221, v221, v21
    v_mul_f32 v222, v222, v22
    v_mul_f32 v223, v223, v23
    v_cvt_pk_bf16_f32 v216, v216, v220
    v_cvt_pk_bf16_f32 v217, v217, v221
    v_cvt_pk_bf16_f32 v218, v218, v222
    v_cvt_pk_bf16_f32 v219, v219, v223
    ds_write2st64_b32 v12, v208, v216 offset0:96 offset1:97
    ds_write2st64_b32 v13, v209, v217 offset0:98 offset1:99
    ds_write2st64_b32 v14, v210, v218 offset0:100 offset1:101
    ds_write2st64_b32 v15, v211, v219 offset0:102 offset1:103
    s_waitcnt lgkmcnt(0)
    s_barrier
    v_mul_f32 v16, s54, v224
    v_mul_f32 v17, s54, v225
    v_mul_f32 v18, s54, v226
    v_mul_f32 v19, s54, v227
    v_mul_f32 v20, s54, v228
    v_mul_f32 v21, s54, v229
    v_mul_f32 v22, s54, v230
    v_mul_f32 v23, s54, v231
    v_exp_f32 v16, v16
    v_exp_f32 v17, v17
    v_exp_f32 v18, v18
    v_exp_f32 v19, v19
    v_exp_f32 v20, v20
    v_exp_f32 v21, v21
    v_exp_f32 v22, v22
    v_exp_f32 v23, v23
    v_add_f32 v16, 1.0, v16
    v_add_f32 v17, 1.0, v17
    v_add_f32 v18, 1.0, v18
    v_add_f32 v19, 1.0, v19
    v_add_f32 v20, 1.0, v20
    v_add_f32 v21, 1.0, v21
    v_add_f32 v22, 1.0, v22
    v_add_f32 v23, 1.0, v23
    v_rcp_f32 v16, v16
    v_rcp_f32 v17, v17
    v_rcp_f32 v18, v18
    v_rcp_f32 v19, v19
    v_rcp_f32 v20, v20
    v_rcp_f32 v21, v21
    v_rcp_f32 v22, v22
    v_rcp_f32 v23, v23
    v_mul_f32 v224, v224, v16
    v_mul_f32 v225, v225, v17
    v_mul_f32 v226, v226, v18
    v_mul_f32 v227, v227, v19
    v_mul_f32 v228, v228, v20
    v_mul_f32 v229, v229, v21
    v_mul_f32 v230, v230, v22
    v_mul_f32 v231, v231, v23
    v_cvt_pk_bf16_f32 v224, v224, v228
    v_cvt_pk_bf16_f32 v225, v225, v229
    v_cvt_pk_bf16_f32 v226, v226, v230
    v_cvt_pk_bf16_f32 v227, v227, v231
    v_mul_f32 v16, s54, v232
    v_mul_f32 v17, s54, v233
    v_mul_f32 v18, s54, v234
    v_mul_f32 v19, s54, v235
    v_mul_f32 v20, s54, v236
    v_mul_f32 v21, s54, v237
    v_mul_f32 v22, s54, v238
    v_mul_f32 v23, s54, v239
    v_exp_f32 v16, v16
    v_exp_f32 v17, v17
    v_exp_f32 v18, v18
    v_exp_f32 v19, v19
    v_exp_f32 v20, v20
    v_exp_f32 v21, v21
    v_exp_f32 v22, v22
    v_exp_f32 v23, v23
    v_add_f32 v16, 1.0, v16
    v_add_f32 v17, 1.0, v17
    v_add_f32 v18, 1.0, v18
    v_add_f32 v19, 1.0, v19
    v_add_f32 v20, 1.0, v20
    v_add_f32 v21, 1.0, v21
    v_add_f32 v22, 1.0, v22
    v_add_f32 v23, 1.0, v23
    v_rcp_f32 v16, v16
    v_rcp_f32 v17, v17
    v_rcp_f32 v18, v18
    v_rcp_f32 v19, v19
    v_rcp_f32 v20, v20
    v_rcp_f32 v21, v21
    v_rcp_f32 v22, v22
    v_rcp_f32 v23, v23
    v_mul_f32 v232, v232, v16
    v_mul_f32 v233, v233, v17
    v_mul_f32 v234, v234, v18
    v_mul_f32 v235, v235, v19
    v_mul_f32 v236, v236, v20
    v_mul_f32 v237, v237, v21
    v_mul_f32 v238, v238, v22
    v_mul_f32 v239, v239, v23
    v_cvt_pk_bf16_f32 v232, v232, v236
    v_cvt_pk_bf16_f32 v233, v233, v237
    v_cvt_pk_bf16_f32 v234, v234, v238
    v_cvt_pk_bf16_f32 v235, v235, v239
    ds_write2st64_b32 v12, v224, v232 offset0:128 offset1:129
    ds_write2st64_b32 v13, v225, v233 offset0:130 offset1:131
    ds_write2st64_b32 v14, v226, v234 offset0:132 offset1:133
    ds_write2st64_b32 v15, v227, v235 offset0:134 offset1:135
    s_waitcnt lgkmcnt(0)
    s_barrier
    v_mul_f32 v16, s54, v240
    v_mul_f32 v17, s54, v241
    v_mul_f32 v18, s54, v242
    v_mul_f32 v19, s54, v243
    v_mul_f32 v20, s54, v244
    v_mul_f32 v21, s54, v245
    v_mul_f32 v22, s54, v246
    v_mul_f32 v23, s54, v247
    v_exp_f32 v16, v16
    v_exp_f32 v17, v17
    v_exp_f32 v18, v18
    v_exp_f32 v19, v19
    v_exp_f32 v20, v20
    v_exp_f32 v21, v21
    v_exp_f32 v22, v22
    v_exp_f32 v23, v23
    v_add_f32 v16, 1.0, v16
    v_add_f32 v17, 1.0, v17
    v_add_f32 v18, 1.0, v18
    v_add_f32 v19, 1.0, v19
    v_add_f32 v20, 1.0, v20
    v_add_f32 v21, 1.0, v21
    v_add_f32 v22, 1.0, v22
    v_add_f32 v23, 1.0, v23
    v_rcp_f32 v16, v16
    v_rcp_f32 v17, v17
    v_rcp_f32 v18, v18
    v_rcp_f32 v19, v19
    v_rcp_f32 v20, v20
    v_rcp_f32 v21, v21
    v_rcp_f32 v22, v22
    v_rcp_f32 v23, v23
    v_mul_f32 v240, v240, v16
    v_mul_f32 v241, v241, v17
    v_mul_f32 v242, v242, v18
    v_mul_f32 v243, v243, v19
    v_mul_f32 v244, v244, v20
    v_mul_f32 v245, v245, v21
    v_mul_f32 v246, v246, v22
    v_mul_f32 v247, v247, v23
    v_cvt_pk_bf16_f32 v240, v240, v244
    v_cvt_pk_bf16_f32 v241, v241, v245
    v_cvt_pk_bf16_f32 v242, v242, v246
    v_cvt_pk_bf16_f32 v243, v243, v247
    v_mul_f32 v16, s54, v248
    v_mul_f32 v17, s54, v249
    v_mul_f32 v18, s54, v250
    v_mul_f32 v19, s54, v251
    v_mul_f32 v20, s54, v252
    v_mul_f32 v21, s54, v253
    v_mul_f32 v22, s54, v254
    v_mul_f32 v23, s54, v255
    v_exp_f32 v16, v16
    v_exp_f32 v17, v17
    v_exp_f32 v18, v18
    v_exp_f32 v19, v19
    v_exp_f32 v20, v20
    v_exp_f32 v21, v21
    v_exp_f32 v22, v22
    v_exp_f32 v23, v23
    v_add_f32 v16, 1.0, v16
    v_add_f32 v17, 1.0, v17
    v_add_f32 v18, 1.0, v18
    v_add_f32 v19, 1.0, v19
    v_add_f32 v20, 1.0, v20
    v_add_f32 v21, 1.0, v21
    v_add_f32 v22, 1.0, v22
    v_add_f32 v23, 1.0, v23
    v_rcp_f32 v16, v16
    v_rcp_f32 v17, v17
    v_rcp_f32 v18, v18
    v_rcp_f32 v19, v19
    v_rcp_f32 v20, v20
    v_rcp_f32 v21, v21
    v_rcp_f32 v22, v22
    v_rcp_f32 v23, v23
    v_mul_f32 v248, v248, v16
    v_mul_f32 v249, v249, v17
    v_mul_f32 v250, v250, v18
    v_mul_f32 v251, v251, v19
    v_mul_f32 v252, v252, v20
    v_mul_f32 v253, v253, v21
    v_mul_f32 v254, v254, v22
    v_mul_f32 v255, v255, v23
    v_cvt_pk_bf16_f32 v248, v248, v252
    v_cvt_pk_bf16_f32 v249, v249, v253
    v_cvt_pk_bf16_f32 v250, v250, v254
    v_cvt_pk_bf16_f32 v251, v251, v255
    ds_write2st64_b32 v12, v240, v248 offset0:160 offset1:161
    ds_write2st64_b32 v13, v241, v249 offset0:162 offset1:163
    ds_write2st64_b32 v14, v242, v250 offset0:164 offset1:165
    ds_write2st64_b32 v15, v243, v251 offset0:166 offset1:167
    s_setprio 0
    s_waitcnt lgkmcnt(0)
    s_barrier
    v_and_b32 v16, 63, v0
    v_lshrrev_b32 v17, 4, v16
    v_bfe_u32 v18, v16, 2, 2
    v_and_b32 v19, 1, v17
    v_lshl_or_b32 v19, v19, 2, v18
    v_lshlrev_b32 v19, 1, v19
    v_and_b32 v20, 3, v16
    s_lshl_b32 s52, s61, 2
    v_or_b32 v21, s52, v20
    v_xor_b32 v19, v19, v21
    v_lshl_add_u32 v21, v17, 3, v18
    v_lshlrev_b32 v21, 9, v21
    v_lshl_add_u32 v9, v19, 4, v21
    v_add_u32 v9, 73728, v9
    v_lshl_add_u32 v17, v17, 2, s57
    v_mul_u32_u24 v17, 640, v17
    v_lshl_add_u32 v17, v18, 4, v17
    v_and_b32 v19, 1, v16
    v_lshl_add_u32 v17, v19, 3, v17
    v_bfe_u32 v19, v16, 1, 1
    v_lshl_add_u32 v17, v19, 2, v17
    s_and_b32 s52, s3, 1
    s_lshl_b32 s52, s52, 6
    s_add_u32 s52, s52, 512
    v_add_u32 v1, s52, v17
    v_mov_b32 v19, 0x03020706
    v_mov_b32 v20, 0x05040100
    v_mov_b32 v21, 0x8000
    v_cndmask_b32 v2, v19, v20, s[80:81]
    v_cndmask_b32 v4, 0, v21, s[80:81]
    ds_read_b128 v[32:35], v5 offset:0
    ds_read_b128 v[36:39], v5 offset:8192
    ds_read_b128 v[40:43], v5 offset:16384
    ds_read_b128 v[44:47], v5 offset:24576
    ds_read_b128 v[48:51], v5 offset:32768
    ds_read_b128 v[52:55], v5 offset:40960
    v_xor_b32 v6, 64, v5
    ds_read_b128 v[56:59], v6 offset:0
    ds_read_b128 v[60:63], v6 offset:8192
    ds_read_b128 v[64:67], v6 offset:16384
    ds_read_b128 v[68:71], v6 offset:24576
    v_lshlrev_b32 v16, 3, v0
    v_add_u32 v16, 153600, v16
    v_mov_b32 v17, 0
    v_cmp_gt_u32 vcc, 456, v0
    s_and_b64 exec, exec, vcc
    ds_write2_b32 v16, v17, v17 offset0:0 offset1:1
    s_mov_b64 exec, -1
    s_waitcnt lgkmcnt(0)
    ds_read_b64_tr_b16 v[192:193], v9 offset:0
    ds_read_b64_tr_b16 v[194:195], v9 offset:2048
    ds_read_b64_tr_b16 v[196:197], v9 offset:8
    ds_read_b64_tr_b16 v[198:199], v9 offset:2056
    ds_read_b64_tr_b16 v[200:201], v9 offset:256
    ds_read_b64_tr_b16 v[202:203], v9 offset:2304
    ds_read_b64_tr_b16 v[204:205], v9 offset:264
    ds_read_b64_tr_b16 v[206:207], v9 offset:2312
    ds_read_b64_tr_b16 v[208:209], v9 offset:16384
    ds_read_b64_tr_b16 v[210:211], v9 offset:18432
    ds_read_b64_tr_b16 v[212:213], v9 offset:16392
    ds_read_b64_tr_b16 v[214:215], v9 offset:18440
    s_waitcnt lgkmcnt(6)
    ds_read_b64_tr_b16 v[216:217], v9 offset:16640
    ds_read_b64_tr_b16 v[218:219], v9 offset:18688
    ds_read_b64_tr_b16 v[220:221], v9 offset:16648
    ds_read_b64_tr_b16 v[222:223], v9 offset:18696
    s_waitcnt lgkmcnt(0)
    s_barrier
    s_add_u32 m0, s58, 73728
    s_min_u32 s48, s76, s77
    s_add_u32 s48, s48, 1024
    buffer_load_dwordx4 v3, s[36:39], s48 offen lds
    s_add_u32 m0, s58, 75776
    s_min_u32 s48, s76, s77
    s_add_u32 s48, s48, 4096
    buffer_load_dwordx4 v3, s[36:39], s48 offen lds
    s_add_u32 m0, s58, 81920
    s_min_u32 s48, s76, s77
    s_add_u32 s48, s48, 13312
    buffer_load_dwordx4 v3, s[36:39], s48 offen lds
    s_add_u32 m0, s58, 83968
    s_min_u32 s48, s76, s77
    s_add_u32 s48, s48, 16384
    buffer_load_dwordx4 v3, s[36:39], s48 offen lds
    s_add_u32 m0, s58, 90112
    s_min_u32 s48, s78, s79
    s_add_u32 s48, s48, 1024
    buffer_load_dwordx4 v3, s[36:39], s48 offen lds
    s_add_u32 m0, s58, 92160
    s_min_u32 s48, s78, s79
    s_add_u32 s48, s48, 4096
    buffer_load_dwordx4 v3, s[36:39], s48 offen lds
    s_add_u32 m0, s58, 98304
    s_min_u32 s48, s78, s79
    s_add_u32 s48, s48, 13312
    buffer_load_dwordx4 v3, s[36:39], s48 offen lds
    s_add_u32 m0, s58, 100352
    s_min_u32 s48, s78, s79
    s_add_u32 s48, s48, 16384
    buffer_load_dwordx4 v3, s[36:39], s48 offen lds
    v_mfma_f32_16x16x32_bf16 v[144:147], v[32:35], v[192:195], 0
    v_mfma_f32_16x16x32_bf16 v[148:151], v[32:35], v[196:199], 0
    ds_read_b128 v[72:75], v6 offset:32768
    v_mfma_f32_16x16x32_bf16 v[152:155], v[36:39], v[192:195], 0
    v_mfma_f32_16x16x32_bf16 v[156:159], v[36:39], v[196:199], 0
    ds_read_b128 v[76:79], v6 offset:40960
    v_mfma_f32_16x16x32_bf16 v[160:163], v[40:43], v[192:195], 0
    v_xor_b32 v6, 128, v5
    v_mfma_f32_16x16x32_bf16 v[164:167], v[40:43], v[196:199], 0
    ds_read_b128 v[80:83], v6 offset:0
    v_mfma_f32_16x16x32_bf16 v[168:171], v[44:47], v[192:195], 0
    v_mfma_f32_16x16x32_bf16 v[172:175], v[44:47], v[196:199], 0
    ds_read_b128 v[84:87], v6 offset:8192
    v_mfma_f32_16x16x32_bf16 v[176:179], v[48:51], v[192:195], 0
    v_mfma_f32_16x16x32_bf16 v[180:183], v[48:51], v[196:199], 0
    ds_read_b128 v[88:91], v6 offset:16384
    v_mfma_f32_16x16x32_bf16 v[184:187], v[52:55], v[192:195], 0
    v_mfma_f32_16x16x32_bf16 v[188:191], v[52:55], v[196:199], 0
    ds_read_b128 v[92:95], v6 offset:24576
    v_mfma_f32_16x16x32_bf16 v[144:147], v[56:59], v[200:203], v[144:147]
    v_mfma_f32_16x16x32_bf16 v[148:151], v[56:59], v[204:207], v[148:151]
    ds_read_b128 v[96:99], v6 offset:32768
    v_mfma_f32_16x16x32_bf16 v[152:155], v[60:63], v[200:203], v[152:155]
    v_mfma_f32_16x16x32_bf16 v[156:159], v[60:63], v[204:207], v[156:159]
    ds_read_b128 v[100:103], v6 offset:40960
    v_mfma_f32_16x16x32_bf16 v[160:163], v[64:67], v[200:203], v[160:163]
    v_xor_b32 v6, 192, v5
    v_mfma_f32_16x16x32_bf16 v[164:167], v[64:67], v[204:207], v[164:167]
    ds_read_b128 v[104:107], v6 offset:0
    v_mfma_f32_16x16x32_bf16 v[168:171], v[68:71], v[200:203], v[168:171]
    v_mfma_f32_16x16x32_bf16 v[172:175], v[68:71], v[204:207], v[172:175]
    ds_read_b128 v[108:111], v6 offset:8192
    s_waitcnt lgkmcnt(9)
    v_mfma_f32_16x16x32_bf16 v[176:179], v[72:75], v[200:203], v[176:179]
    v_mfma_f32_16x16x32_bf16 v[180:183], v[72:75], v[204:207], v[180:183]
    ds_read_b128 v[112:115], v6 offset:16384
    s_waitcnt lgkmcnt(9)
    v_mfma_f32_16x16x32_bf16 v[184:187], v[76:79], v[200:203], v[184:187]
    v_mfma_f32_16x16x32_bf16 v[188:191], v[76:79], v[204:207], v[188:191]
    ds_read_b128 v[116:119], v6 offset:24576
    s_waitcnt lgkmcnt(9)
    v_mfma_f32_16x16x32_bf16 v[144:147], v[80:83], v[208:211], v[144:147]
    v_mfma_f32_16x16x32_bf16 v[148:151], v[80:83], v[212:215], v[148:151]
    ds_read_b128 v[120:123], v6 offset:32768
    s_waitcnt lgkmcnt(9)
    v_mfma_f32_16x16x32_bf16 v[152:155], v[84:87], v[208:211], v[152:155]
    v_mfma_f32_16x16x32_bf16 v[156:159], v[84:87], v[212:215], v[156:159]
    ds_read_b128 v[124:127], v6 offset:40960
    s_waitcnt lgkmcnt(9)
    v_mfma_f32_16x16x32_bf16 v[160:163], v[88:91], v[208:211], v[160:163]
    v_xor_b32 v6, 256, v5
    v_mfma_f32_16x16x32_bf16 v[164:167], v[88:91], v[212:215], v[164:167]
    ds_read_b128 v[32:35], v6 offset:0
    s_waitcnt lgkmcnt(9)
    v_mfma_f32_16x16x32_bf16 v[168:171], v[92:95], v[208:211], v[168:171]
    v_mfma_f32_16x16x32_bf16 v[172:175], v[92:95], v[212:215], v[172:175]
    ds_read_b128 v[36:39], v6 offset:8192
    s_waitcnt lgkmcnt(9)
    v_mfma_f32_16x16x32_bf16 v[176:179], v[96:99], v[208:211], v[176:179]
    v_mfma_f32_16x16x32_bf16 v[180:183], v[96:99], v[212:215], v[180:183]
    ds_read_b128 v[40:43], v6 offset:16384
    s_waitcnt lgkmcnt(9)
    v_mfma_f32_16x16x32_bf16 v[184:187], v[100:103], v[208:211], v[184:187]
    v_mfma_f32_16x16x32_bf16 v[188:191], v[100:103], v[212:215], v[188:191]
    ds_read_b128 v[44:47], v6 offset:24576
    s_waitcnt lgkmcnt(9)
    v_mfma_f32_16x16x32_bf16 v[144:147], v[104:107], v[216:219], v[144:147]
    v_mfma_f32_16x16x32_bf16 v[148:151], v[104:107], v[220:223], v[148:151]
    ds_read_b128 v[48:51], v6 offset:32768
    s_waitcnt lgkmcnt(9)
    v_mfma_f32_16x16x32_bf16 v[152:155], v[108:111], v[216:219], v[152:155]
    v_mfma_f32_16x16x32_bf16 v[156:159], v[108:111], v[220:223], v[156:159]
    ds_read_b128 v[52:55], v6 offset:40960
    s_waitcnt lgkmcnt(9)
    v_mfma_f32_16x16x32_bf16 v[160:163], v[112:115], v[216:219], v[160:163]
    v_xor_b32 v6, 320, v5
    v_mfma_f32_16x16x32_bf16 v[164:167], v[112:115], v[220:223], v[164:167]
    ds_read_b128 v[56:59], v6 offset:0
    s_waitcnt lgkmcnt(9)
    v_mfma_f32_16x16x32_bf16 v[168:171], v[116:119], v[216:219], v[168:171]
    v_mfma_f32_16x16x32_bf16 v[172:175], v[116:119], v[220:223], v[172:175]
    ds_read_b128 v[60:63], v6 offset:8192
    s_waitcnt lgkmcnt(9)
    v_mfma_f32_16x16x32_bf16 v[176:179], v[120:123], v[216:219], v[176:179]
    v_mfma_f32_16x16x32_bf16 v[180:183], v[120:123], v[220:223], v[180:183]
    ds_read_b128 v[64:67], v6 offset:16384
    s_waitcnt lgkmcnt(9)
    v_mfma_f32_16x16x32_bf16 v[184:187], v[124:127], v[216:219], v[184:187]
    v_mfma_f32_16x16x32_bf16 v[188:191], v[124:127], v[220:223], v[188:191]
    ds_read_b128 v[68:71], v6 offset:24576
    s_waitcnt lgkmcnt(0)
    s_waitcnt vmcnt(0)
    s_barrier
    ds_read_b64_tr_b16 v[224:225], v9 offset:0
    ds_read_b64_tr_b16 v[226:227], v9 offset:2048
    ds_read_b64_tr_b16 v[228:229], v9 offset:8
    ds_read_b64_tr_b16 v[230:231], v9 offset:2056
    ds_read_b64_tr_b16 v[232:233], v9 offset:256
    ds_read_b64_tr_b16 v[234:235], v9 offset:2304
    ds_read_b64_tr_b16 v[236:237], v9 offset:264
    ds_read_b64_tr_b16 v[238:239], v9 offset:2312
    ds_read_b64_tr_b16 v[240:241], v9 offset:16384
    ds_read_b64_tr_b16 v[242:243], v9 offset:18432
    ds_read_b64_tr_b16 v[244:245], v9 offset:16392
    ds_read_b64_tr_b16 v[246:247], v9 offset:18440
    s_waitcnt lgkmcnt(6)
    ds_read_b64_tr_b16 v[248:249], v9 offset:16640
    ds_read_b64_tr_b16 v[250:251], v9 offset:18688
    ds_read_b64_tr_b16 v[252:253], v9 offset:16648
    ds_read_b64_tr_b16 v[254:255], v9 offset:18696
    s_mov_b32 s44, s22
    s_mov_b32 s45, s23
    s_mov_b32 s46, 256
    s_mov_b32 s47, 0x20000
    s_add_u32 s32, s24, 25600000
    s_addc_u32 s33, s25, 0
    s_mov_b32 s34, 142080
    s_mov_b32 s35, 0x20000
    s_lshr_b32 s49, s2, 3
    s_lshl_b32 s49, s49, 4
    s_and_b32 s50, s2, 1
    s_lshl_b32 s50, s50, 3
    s_add_u32 s49, s49, s50
    s_add_u32 s49, s49, 141312
    v_mov_b32 v16, 0
    s_mov_b64 exec, 1
    buffer_load_dwordx2 v[12:13], v16, s[44:47], 0 offen sc1
    buffer_load_dwordx2 v[14:15], v16, s[32:35], s49 offen sc1
    s_mov_b64 exec, -1
    s_waitcnt lgkmcnt(0)
    v_mfma_f32_16x16x32_bf16 v[144:147], v[32:35], v[224:227], v[144:147]
    v_mfma_f32_16x16x32_bf16 v[148:151], v[32:35], v[228:231], v[148:151]
    ds_read_b128 v[72:75], v6 offset:32768
    v_mfma_f32_16x16x32_bf16 v[152:155], v[36:39], v[224:227], v[152:155]
    v_mfma_f32_16x16x32_bf16 v[156:159], v[36:39], v[228:231], v[156:159]
    ds_read_b128 v[76:79], v6 offset:40960
    v_mfma_f32_16x16x32_bf16 v[160:163], v[40:43], v[224:227], v[160:163]
    v_xor_b32 v6, 384, v5
    v_mfma_f32_16x16x32_bf16 v[164:167], v[40:43], v[228:231], v[164:167]
    ds_read_b128 v[80:83], v6 offset:0
    v_mfma_f32_16x16x32_bf16 v[168:171], v[44:47], v[224:227], v[168:171]
    v_mfma_f32_16x16x32_bf16 v[172:175], v[44:47], v[228:231], v[172:175]
    ds_read_b128 v[84:87], v6 offset:8192
    v_mfma_f32_16x16x32_bf16 v[176:179], v[48:51], v[224:227], v[176:179]
    v_mfma_f32_16x16x32_bf16 v[180:183], v[48:51], v[228:231], v[180:183]
    ds_read_b128 v[88:91], v6 offset:16384
    v_mfma_f32_16x16x32_bf16 v[184:187], v[52:55], v[224:227], v[184:187]
    v_mfma_f32_16x16x32_bf16 v[188:191], v[52:55], v[228:231], v[188:191]
    ds_read_b128 v[92:95], v6 offset:24576
    v_mfma_f32_16x16x32_bf16 v[144:147], v[56:59], v[232:235], v[144:147]
    v_mfma_f32_16x16x32_bf16 v[148:151], v[56:59], v[236:239], v[148:151]
    ds_read_b128 v[96:99], v6 offset:32768
    v_mfma_f32_16x16x32_bf16 v[152:155], v[60:63], v[232:235], v[152:155]
    v_mfma_f32_16x16x32_bf16 v[156:159], v[60:63], v[236:239], v[156:159]
    ds_read_b128 v[100:103], v6 offset:40960
    v_mfma_f32_16x16x32_bf16 v[160:163], v[64:67], v[232:235], v[160:163]
    v_xor_b32 v6, 448, v5
    v_mfma_f32_16x16x32_bf16 v[164:167], v[64:67], v[236:239], v[164:167]
    ds_read_b128 v[104:107], v6 offset:0
    v_mfma_f32_16x16x32_bf16 v[168:171], v[68:71], v[232:235], v[168:171]
    v_mfma_f32_16x16x32_bf16 v[172:175], v[68:71], v[236:239], v[172:175]
    ds_read_b128 v[108:111], v6 offset:8192
    s_waitcnt lgkmcnt(9)
    v_mfma_f32_16x16x32_bf16 v[176:179], v[72:75], v[232:235], v[176:179]
    v_mfma_f32_16x16x32_bf16 v[180:183], v[72:75], v[236:239], v[180:183]
    ds_read_b128 v[112:115], v6 offset:16384
    s_waitcnt lgkmcnt(9)
    v_mfma_f32_16x16x32_bf16 v[184:187], v[76:79], v[232:235], v[184:187]
    v_mfma_f32_16x16x32_bf16 v[188:191], v[76:79], v[236:239], v[188:191]
    ds_read_b128 v[116:119], v6 offset:24576
    s_waitcnt lgkmcnt(9)
    v_mfma_f32_16x16x32_bf16 v[144:147], v[80:83], v[240:243], v[144:147]
    v_mfma_f32_16x16x32_bf16 v[148:151], v[80:83], v[244:247], v[148:151]
    ds_read_b128 v[120:123], v6 offset:32768
    s_waitcnt lgkmcnt(9)
    v_mfma_f32_16x16x32_bf16 v[152:155], v[84:87], v[240:243], v[152:155]
    v_mfma_f32_16x16x32_bf16 v[156:159], v[84:87], v[244:247], v[156:159]
    ds_read_b128 v[124:127], v6 offset:40960
    s_waitcnt lgkmcnt(9)
    v_mfma_f32_16x16x32_bf16 v[160:163], v[88:91], v[240:243], v[160:163]
    v_mfma_f32_16x16x32_bf16 v[164:167], v[88:91], v[244:247], v[164:167]
    s_waitcnt lgkmcnt(8)
    v_mfma_f32_16x16x32_bf16 v[168:171], v[92:95], v[240:243], v[168:171]
    v_mfma_f32_16x16x32_bf16 v[172:175], v[92:95], v[244:247], v[172:175]
    s_waitcnt lgkmcnt(7)
    v_mfma_f32_16x16x32_bf16 v[176:179], v[96:99], v[240:243], v[176:179]
    v_mfma_f32_16x16x32_bf16 v[180:183], v[96:99], v[244:247], v[180:183]
    s_waitcnt lgkmcnt(6)
    v_mfma_f32_16x16x32_bf16 v[184:187], v[100:103], v[240:243], v[184:187]
    v_mfma_f32_16x16x32_bf16 v[188:191], v[100:103], v[244:247], v[188:191]
    s_waitcnt lgkmcnt(5)
    v_mfma_f32_16x16x32_bf16 v[144:147], v[104:107], v[248:251], v[144:147]
    v_mfma_f32_16x16x32_bf16 v[148:151], v[104:107], v[252:255], v[148:151]
    s_waitcnt lgkmcnt(4)
    v_mfma_f32_16x16x32_bf16 v[152:155], v[108:111], v[248:251], v[152:155]
    v_mfma_f32_16x16x32_bf16 v[156:159], v[108:111], v[252:255], v[156:159]
    s_waitcnt lgkmcnt(3)
    v_mfma_f32_16x16x32_bf16 v[160:163], v[112:115], v[248:251], v[160:163]
    v_mfma_f32_16x16x32_bf16 v[164:167], v[112:115], v[252:255], v[164:167]
    s_waitcnt lgkmcnt(2)
    v_mfma_f32_16x16x32_bf16 v[168:171], v[116:119], v[248:251], v[168:171]
    v_mfma_f32_16x16x32_bf16 v[172:175], v[116:119], v[252:255], v[172:175]
    s_waitcnt lgkmcnt(1)
    v_mfma_f32_16x16x32_bf16 v[176:179], v[120:123], v[248:251], v[176:179]
    v_mfma_f32_16x16x32_bf16 v[180:183], v[120:123], v[252:255], v[180:183]
    s_waitcnt lgkmcnt(0)
    v_mfma_f32_16x16x32_bf16 v[184:187], v[124:127], v[248:251], v[184:187]
    v_mfma_f32_16x16x32_bf16 v[188:191], v[124:127], v[252:255], v[188:191]
    s_nop 7
    v_add_u32 v144, v144, v4
    v_add_u32 v148, v148, v4
    v_add_u32 v145, v145, v4
    v_add_u32 v149, v149, v4
    v_add_u32 v146, v146, v4
    v_add_u32 v150, v150, v4
    v_add_u32 v147, v147, v4
    v_add_u32 v151, v151, v4
    v_perm_b32 v16, v148, v144, s56
    v_perm_b32 v17, v149, v145, s56
    v_perm_b32 v18, v150, v146, s56
    v_perm_b32 v19, v151, v147, s56
    s_mov_b32 s52, 0
    v_mov_b32_dpp v20, v16 quad_perm:[1,0,3,2] row_mask:0xf bank_mask:0xf
    v_mov_b32_dpp v21, v17 quad_perm:[1,0,3,2] row_mask:0xf bank_mask:0xf
    v_mov_b32_dpp v22, v18 quad_perm:[1,0,3,2] row_mask:0xf bank_mask:0xf
    v_mov_b32_dpp v23, v19 quad_perm:[1,0,3,2] row_mask:0xf bank_mask:0xf
    v_perm_b32 v144, v20, v16, v2
    buffer_store_dword v144, v1, s[40:43], s52 offen offset:0 sc1
    v_perm_b32 v145, v21, v17, v2
    buffer_store_dword v145, v1, s[40:43], s52 offen offset:640 sc1
    v_perm_b32 v146, v22, v18, v2
    buffer_store_dword v146, v1, s[40:43], s52 offen offset:1280 sc1
    v_perm_b32 v147, v23, v19, v2
    buffer_store_dword v147, v1, s[40:43], s52 offen offset:1920 sc1
    v_add_u32 v152, v152, v4
    v_add_u32 v156, v156, v4
    v_add_u32 v153, v153, v4
    v_add_u32 v157, v157, v4
    v_add_u32 v154, v154, v4
    v_add_u32 v158, v158, v4
    v_add_u32 v155, v155, v4
    v_add_u32 v159, v159, v4
    v_perm_b32 v16, v156, v152, s56
    v_perm_b32 v17, v157, v153, s56
    v_perm_b32 v18, v158, v154, s56
    v_perm_b32 v19, v159, v155, s56
    s_mov_b32 s52, 10240
    v_mov_b32_dpp v20, v16 quad_perm:[1,0,3,2] row_mask:0xf bank_mask:0xf
    v_mov_b32_dpp v21, v17 quad_perm:[1,0,3,2] row_mask:0xf bank_mask:0xf
    v_mov_b32_dpp v22, v18 quad_perm:[1,0,3,2] row_mask:0xf bank_mask:0xf
    v_mov_b32_dpp v23, v19 quad_perm:[1,0,3,2] row_mask:0xf bank_mask:0xf
    v_perm_b32 v152, v20, v16, v2
    buffer_store_dword v152, v1, s[40:43], s52 offen offset:0 sc1
    v_perm_b32 v153, v21, v17, v2
    buffer_store_dword v153, v1, s[40:43], s52 offen offset:640 sc1
    v_perm_b32 v154, v22, v18, v2
    buffer_store_dword v154, v1, s[40:43], s52 offen offset:1280 sc1
    v_perm_b32 v155, v23, v19, v2
    buffer_store_dword v155, v1, s[40:43], s52 offen offset:1920 sc1
    v_add_u32 v160, v160, v4
    v_add_u32 v164, v164, v4
    v_add_u32 v161, v161, v4
    v_add_u32 v165, v165, v4
    v_add_u32 v162, v162, v4
    v_add_u32 v166, v166, v4
    v_add_u32 v163, v163, v4
    v_add_u32 v167, v167, v4
    v_perm_b32 v16, v164, v160, s56
    v_perm_b32 v17, v165, v161, s56
    v_perm_b32 v18, v166, v162, s56
    v_perm_b32 v19, v167, v163, s56
    s_mov_b32 s52, 20480
    v_mov_b32_dpp v20, v16 quad_perm:[1,0,3,2] row_mask:0xf bank_mask:0xf
    v_mov_b32_dpp v21, v17 quad_perm:[1,0,3,2] row_mask:0xf bank_mask:0xf
    v_mov_b32_dpp v22, v18 quad_perm:[1,0,3,2] row_mask:0xf bank_mask:0xf
    v_mov_b32_dpp v23, v19 quad_perm:[1,0,3,2] row_mask:0xf bank_mask:0xf
    v_perm_b32 v160, v20, v16, v2
    buffer_store_dword v160, v1, s[40:43], s52 offen offset:0 sc1
    v_perm_b32 v161, v21, v17, v2
    buffer_store_dword v161, v1, s[40:43], s52 offen offset:640 sc1
    v_perm_b32 v162, v22, v18, v2
    buffer_store_dword v162, v1, s[40:43], s52 offen offset:1280 sc1
    v_perm_b32 v163, v23, v19, v2
    buffer_store_dword v163, v1, s[40:43], s52 offen offset:1920 sc1
    v_add_u32 v168, v168, v4
    v_add_u32 v172, v172, v4
    v_add_u32 v169, v169, v4
    v_add_u32 v173, v173, v4
    v_add_u32 v170, v170, v4
    v_add_u32 v174, v174, v4
    v_add_u32 v171, v171, v4
    v_add_u32 v175, v175, v4
    v_perm_b32 v16, v172, v168, s56
    v_perm_b32 v17, v173, v169, s56
    v_perm_b32 v18, v174, v170, s56
    v_perm_b32 v19, v175, v171, s56
    s_mov_b32 s52, 30720
    v_mov_b32_dpp v20, v16 quad_perm:[1,0,3,2] row_mask:0xf bank_mask:0xf
    v_mov_b32_dpp v21, v17 quad_perm:[1,0,3,2] row_mask:0xf bank_mask:0xf
    v_mov_b32_dpp v22, v18 quad_perm:[1,0,3,2] row_mask:0xf bank_mask:0xf
    v_mov_b32_dpp v23, v19 quad_perm:[1,0,3,2] row_mask:0xf bank_mask:0xf
    v_perm_b32 v168, v20, v16, v2
    buffer_store_dword v168, v1, s[40:43], s52 offen offset:0 sc1
    v_perm_b32 v169, v21, v17, v2
    buffer_store_dword v169, v1, s[40:43], s52 offen offset:640 sc1
    v_perm_b32 v170, v22, v18, v2
    buffer_store_dword v170, v1, s[40:43], s52 offen offset:1280 sc1
    v_perm_b32 v171, v23, v19, v2
    buffer_store_dword v171, v1, s[40:43], s52 offen offset:1920 sc1
    v_add_u32 v176, v176, v4
    v_add_u32 v180, v180, v4
    v_add_u32 v177, v177, v4
    v_add_u32 v181, v181, v4
    v_add_u32 v178, v178, v4
    v_add_u32 v182, v182, v4
    v_add_u32 v179, v179, v4
    v_add_u32 v183, v183, v4
    v_perm_b32 v16, v180, v176, s56
    v_perm_b32 v17, v181, v177, s56
    v_perm_b32 v18, v182, v178, s56
    v_perm_b32 v19, v183, v179, s56
    s_mov_b32 s52, 40960
    v_mov_b32_dpp v20, v16 quad_perm:[1,0,3,2] row_mask:0xf bank_mask:0xf
    v_mov_b32_dpp v21, v17 quad_perm:[1,0,3,2] row_mask:0xf bank_mask:0xf
    v_mov_b32_dpp v22, v18 quad_perm:[1,0,3,2] row_mask:0xf bank_mask:0xf
    v_mov_b32_dpp v23, v19 quad_perm:[1,0,3,2] row_mask:0xf bank_mask:0xf
    v_perm_b32 v176, v20, v16, v2
    buffer_store_dword v176, v1, s[40:43], s52 offen offset:0 sc1
    v_perm_b32 v177, v21, v17, v2
    buffer_store_dword v177, v1, s[40:43], s52 offen offset:640 sc1
    v_perm_b32 v178, v22, v18, v2
    buffer_store_dword v178, v1, s[40:43], s52 offen offset:1280 sc1
    v_perm_b32 v179, v23, v19, v2
    buffer_store_dword v179, v1, s[40:43], s52 offen offset:1920 sc1
    v_add_u32 v184, v184, v4
    v_add_u32 v188, v188, v4
    v_add_u32 v185, v185, v4
    v_add_u32 v189, v189, v4
    v_add_u32 v186, v186, v4
    v_add_u32 v190, v190, v4
    v_add_u32 v187, v187, v4
    v_add_u32 v191, v191, v4
    v_perm_b32 v16, v188, v184, s56
    v_perm_b32 v17, v189, v185, s56
    v_perm_b32 v18, v190, v186, s56
    v_perm_b32 v19, v191, v187, s56
    s_mov_b32 s52, 51200
    v_mov_b32_dpp v20, v16 quad_perm:[1,0,3,2] row_mask:0xf bank_mask:0xf
    v_mov_b32_dpp v21, v17 quad_perm:[1,0,3,2] row_mask:0xf bank_mask:0xf
    v_mov_b32_dpp v22, v18 quad_perm:[1,0,3,2] row_mask:0xf bank_mask:0xf
    v_mov_b32_dpp v23, v19 quad_perm:[1,0,3,2] row_mask:0xf bank_mask:0xf
    v_perm_b32 v184, v20, v16, v2
    buffer_store_dword v184, v1, s[40:43], s52 offen offset:0 sc1
    v_perm_b32 v185, v21, v17, v2
    buffer_store_dword v185, v1, s[40:43], s52 offen offset:640 sc1
    v_perm_b32 v186, v22, v18, v2
    buffer_store_dword v186, v1, s[40:43], s52 offen offset:1280 sc1
    v_perm_b32 v187, v23, v19, v2
    buffer_store_dword v187, v1, s[40:43], s52 offen offset:1920 sc1
K1_GFIN_26:
P2_1:
    s_bfe_u32 s52, s2, 0x20001
    s_and_b32 s77, s3, 3
    s_mov_b32 s76, 1
    s_mov_b32 s48, s22
    s_mov_b32 s49, s23
    s_mov_b32 s50, 256
    s_mov_b32 s51, 0x20000
    s_add_u32 s44, s24, 25600000
    s_addc_u32 s45, s25, 0
    s_mov_b32 s46, 142080
    s_mov_b32 s47, 0x20000
    s_mov_b32 s32, s4
    s_mov_b32 s33, s5
    s_mov_b32 s34, 20480000
    s_mov_b32 s35, 0x20000
    s_cmp_ge_u32 s2, 46
    s_cbranch_scc1 K2_SIDE_29
    s_cmp_lt_u32 s3, 4
    s_cbranch_scc1 K2_SZ_30
    v_lshlrev_b32 v41, 3, v0
    v_add_u32 v41, 153600, v41
    v_mov_b32 v42, 0
    v_cmp_gt_u32 vcc, 456, v0
    s_and_b64 exec, exec, vcc
    ds_write2_b32 v41, v42, v42 offset0:0 offset1:1
    s_mov_b64 exec, -1
K2_SZ_30:
    v_mov_b32 v47, 160064
    s_waitcnt vmcnt(0) lgkmcnt(0)
    s_barrier
    s_cmp_lg_u32 s3, 4
    s_cbranch_scc1 K2_S2_34
    v_readfirstlane_b32 s27, v12
    v_readfirstlane_b32 s68, v13
    s_nop 1
    s_lshr_b32 s27, s27, 18
    s_lshr_b32 s68, s68, 18
    s_min_u32 s69, s27, s68
    s_lshl_b32 s68, s68, 14
    s_or_b32 s27, s27, s68
    s_cmp_lg_u32 s69, 0
    s_cbranch_scc1 K2_TOK_37
    s_mov_b32 s67, 131072
K2_SPIN_38:
    s_lshr_b32 s68, s2, 3
    s_lshl_b32 s68, s68, 4
    s_and_b32 s69, s2, 1
    s_lshl_b32 s69, s69, 3
    s_add_u32 s68, s68, s69
    s_add_u32 s68, s68, 141312
    v_mov_b32 v41, 0
    s_mov_b64 exec, 1
    buffer_load_dwordx2 v[12:13], v41, s[48:51], 0 offen sc1
    s_mov_b64 exec, -1
    s_waitcnt vmcnt(0)
    v_readfirstlane_b32 s27, v12
    v_readfirstlane_b32 s68, v13
    s_nop 1
    s_lshr_b32 s27, s27, 18
    s_lshr_b32 s68, s68, 18
    s_min_u32 s69, s27, s68
    s_lshl_b32 s68, s68, 14
    s_or_b32 s27, s27, s68
    s_cmp_lg_u32 s69, 0
    s_cbranch_scc1 K2_SPINOK_39
    s_sub_u32 s67, s67, 1
    s_cbranch_scc1 K2_SPINOK_39
    s_sleep 8
    s_branch K2_SPIN_38
K2_SPINOK_39:
K2_TOK_37:
    s_mul_i32 s68, s2, 64
    s_add_u32 s68, s68, 108544
    v_mbcnt_lo_u32_b32 v41, -1, 0
    v_mov_b32 v43, s27
    v_lshlrev_b32 v41, 2, v41
    s_mov_b64 exec, 0xffff
    buffer_store_dword v43, v41, s[44:47], s68 offen sc1
    s_mov_b64 exec, -1
    s_cmp_lg_u32 s2, 45
    s_cbranch_scc1 K2_NOAGG_33
    v_and_b32 v41, 63, v0
    v_add_u32 v100, 0, v41
    v_min_u32 v100, 44, v100
    v_mul_u32_u24 v100, 64, v100
    s_mov_b32 s68, 108544
    s_mov_b64 s[84:85], -1
    s_mov_b32 s67, 131072
K2_SPIN_40:
    s_mov_b64 exec, s[84:85]
    s_cbranch_execz K2_PQ_42
    buffer_load_dword v104, v100, s[44:47], s68 offen sc1
K2_PQ_42:
    s_mov_b64 exec, -1
    s_waitcnt vmcnt(0)
    v_cmp_ne_u32 s[84:85], s27, v104
    s_mov_b64 vcc, s[84:85]
    s_cmp_eq_u64 vcc, 0
    s_cbranch_scc1 K2_SPINOK_41
    s_sub_u32 s67, s67, 1
    s_cbranch_scc1 K2_SPINOK_41
    s_sleep 4
    s_branch K2_SPIN_40
K2_SPINOK_41:
    v_lshlrev_b32 v41, 2, v41
    buffer_load_dword v42, v41, s[48:51], 0 offen sc1
    v_lshrrev_b32 v41, 2, v41
    v_mov_b32 v43, s27
    v_mov_b32 v44, 0
    s_waitcnt vmcnt(0)
    v_and_b32 v42, 0x3ffff, v42
    v_lshl_or_b32 v45, v42, 6, v41
    v_lshl_or_b32 v42, v41, 20, v42
    v_lshlrev_b32 v48, 2, v41
    v_mov_b32 v49, 0
    ds_write_b32 v48, v45
    ds_read_b128 v[142:145], v44 offset:0
    ds_read_b128 v[146:149], v44 offset:16
    ds_read_b128 v[150:153], v44 offset:32
    ds_read_b128 v[154:157], v44 offset:48
    ds_read_b128 v[158:161], v44 offset:64
    ds_read_b128 v[162:165], v44 offset:80
    ds_read_b128 v[166:169], v44 offset:96
    ds_read_b128 v[170:173], v44 offset:112
    s_waitcnt lgkmcnt(4)
    ds_read_b128 v[174:177], v44 offset:128
    ds_read_b128 v[178:181], v44 offset:144
    ds_read_b128 v[182:185], v44 offset:160
    ds_read_b128 v[186:189], v44 offset:176
    ds_read_b128 v[190:193], v44 offset:192
    ds_read_b128 v[194:197], v44 offset:208
    ds_read_b128 v[198:201], v44 offset:224
    ds_read_b128 v[202:205], v44 offset:240
    s_waitcnt lgkmcnt(8)
    v_sub_u32 v142, v45, v142
    v_sub_u32 v143, v45, v143
    v_sub_u32 v144, v45, v144
    v_sub_u32 v145, v45, v145
    v_sub_u32 v146, v45, v146
    v_sub_u32 v147, v45, v147
    v_sub_u32 v148, v45, v148
    v_sub_u32 v149, v45, v149
    v_sub_u32 v150, v45, v150
    v_sub_u32 v151, v45, v151
    v_sub_u32 v152, v45, v152
    v_sub_u32 v153, v45, v153
    v_sub_u32 v154, v45, v154
    v_sub_u32 v155, v45, v155
    v_sub_u32 v156, v45, v156
    v_sub_u32 v157, v45, v157
    v_sub_u32 v158, v45, v158
    v_sub_u32 v159, v45, v159
    v_sub_u32 v160, v45, v160
    v_sub_u32 v161, v45, v161
    v_sub_u32 v162, v45, v162
    v_sub_u32 v163, v45, v163
    v_sub_u32 v164, v45, v164
    v_sub_u32 v165, v45, v165
    v_sub_u32 v166, v45, v166
    v_sub_u32 v167, v45, v167
    v_sub_u32 v168, v45, v168
    v_sub_u32 v169, v45, v169
    v_sub_u32 v170, v45, v170
    v_sub_u32 v171, v45, v171
    v_sub_u32 v172, v45, v172
    v_sub_u32 v173, v45, v173
    v_alignbit_b32 v48, v48, v142, 31
    v_alignbit_b32 v48, v48, v143, 31
    v_alignbit_b32 v48, v48, v144, 31
    v_alignbit_b32 v48, v48, v145, 31
    v_alignbit_b32 v48, v48, v146, 31
    v_alignbit_b32 v48, v48, v147, 31
    v_alignbit_b32 v48, v48, v148, 31
    v_alignbit_b32 v48, v48, v149, 31
    v_alignbit_b32 v48, v48, v150, 31
    v_alignbit_b32 v48, v48, v151, 31
    v_alignbit_b32 v48, v48, v152, 31
    v_alignbit_b32 v48, v48, v153, 31
    v_alignbit_b32 v48, v48, v154, 31
    v_alignbit_b32 v48, v48, v155, 31
    v_alignbit_b32 v48, v48, v156, 31
    v_alignbit_b32 v48, v48, v157, 31
    v_alignbit_b32 v48, v48, v158, 31
    v_alignbit_b32 v48, v48, v159, 31
    v_alignbit_b32 v48, v48, v160, 31
    v_alignbit_b32 v48, v48, v161, 31
    v_alignbit_b32 v48, v48, v162, 31
    v_alignbit_b32 v48, v48, v163, 31
    v_alignbit_b32 v48, v48, v164, 31
    v_alignbit_b32 v48, v48, v165, 31
    v_alignbit_b32 v48, v48, v166, 31
    v_alignbit_b32 v48, v48, v167, 31
    v_alignbit_b32 v48, v48, v168, 31
    v_alignbit_b32 v48, v48, v169, 31
    v_alignbit_b32 v48, v48, v170, 31
    v_alignbit_b32 v48, v48, v171, 31
    v_alignbit_b32 v48, v48, v172, 31
    v_alignbit_b32 v48, v48, v173, 31
    s_waitcnt lgkmcnt(0)
    v_sub_u32 v174, v45, v174
    v_sub_u32 v175, v45, v175
    v_sub_u32 v176, v45, v176
    v_sub_u32 v177, v45, v177
    v_sub_u32 v178, v45, v178
    v_sub_u32 v179, v45, v179
    v_sub_u32 v180, v45, v180
    v_sub_u32 v181, v45, v181
    v_sub_u32 v182, v45, v182
    v_sub_u32 v183, v45, v183
    v_sub_u32 v184, v45, v184
    v_sub_u32 v185, v45, v185
    v_sub_u32 v186, v45, v186
    v_sub_u32 v187, v45, v187
    v_sub_u32 v188, v45, v188
    v_sub_u32 v189, v45, v189
    v_sub_u32 v190, v45, v190
    v_sub_u32 v191, v45, v191
    v_sub_u32 v192, v45, v192
    v_sub_u32 v193, v45, v193
    v_sub_u32 v194, v45, v194
    v_sub_u32 v195, v45, v195
    v_sub_u32 v196, v45, v196
    v_sub_u32 v197, v45, v197
    v_sub_u32 v198, v45, v198
    v_sub_u32 v199, v45, v199
    v_sub_u32 v200, v45, v200
    v_sub_u32 v201, v45, v201
    v_sub_u32 v202, v45, v202
    v_sub_u32 v203, v45, v203
    v_sub_u32 v204, v45, v204
    v_sub_u32 v205, v45, v205
    v_alignbit_b32 v49, v49, v174, 31
    v_alignbit_b32 v49, v49, v175, 31
    v_alignbit_b32 v49, v49, v176, 31
    v_alignbit_b32 v49, v49, v177, 31
    v_alignbit_b32 v49, v49, v178, 31
    v_alignbit_b32 v49, v49, v179, 31
    v_alignbit_b32 v49, v49, v180, 31
    v_alignbit_b32 v49, v49, v181, 31
    v_alignbit_b32 v49, v49, v182, 31
    v_alignbit_b32 v49, v49, v183, 31
    v_alignbit_b32 v49, v49, v184, 31
    v_alignbit_b32 v49, v49, v185, 31
    v_alignbit_b32 v49, v49, v186, 31
    v_alignbit_b32 v49, v49, v187, 31
    v_alignbit_b32 v49, v49, v188, 31
    v_alignbit_b32 v49, v49, v189, 31
    v_alignbit_b32 v49, v49, v190, 31
    v_alignbit_b32 v49, v49, v191, 31
    v_alignbit_b32 v49, v49, v192, 31
    v_alignbit_b32 v49, v49, v193, 31
    v_alignbit_b32 v49, v49, v194, 31
    v_alignbit_b32 v49, v49, v195, 31
    v_alignbit_b32 v49, v49, v196, 31
    v_alignbit_b32 v49, v49, v197, 31
    v_alignbit_b32 v49, v49, v198, 31
    v_alignbit_b32 v49, v49, v199, 31
    v_alignbit_b32 v49, v49, v200, 31
    v_alignbit_b32 v49, v49, v201, 31
    v_alignbit_b32 v49, v49, v202, 31
    v_alignbit_b32 v49, v49, v203, 31
    v_alignbit_b32 v49, v49, v204, 31
    v_alignbit_b32 v49, v49, v205, 31
    v_bcnt_u32_b32 v44, v48, 0
    v_bcnt_u32_b32 v44, v49, v44
    v_lshlrev_b32 v44, 2, v44
    ds_permute_b32 v42, v44, v42
    v_lshlrev_b32 v41, 3, v41
    s_mov_b32 s68, 141312
    s_waitcnt lgkmcnt(0)
    buffer_store_dwordx2 v[42:43], v41, s[44:47], s68 offen sc1
    v_readlane_b32 s68, v42, 11
    v_mov_b32 v15, s27
    s_nop 0
    v_mov_b32 v14, s68
    s_branch K2_AGD_35
K2_NOAGG_33:
    s_mov_b32 s67, 131072
K2_SPIN_43:
    s_lshr_b32 s68, s2, 3
    s_lshl_b32 s68, s68, 4
    s_and_b32 s69, s2, 1
    s_lshl_b32 s69, s69, 3
    s_add_u32 s68, s68, s69
    s_add_u32 s68, s68, 141312
    v_mov_b32 v41, 0
    s_mov_b64 exec, 1
    buffer_load_dwordx2 v[14:15], v41, s[44:47], s68 offen sc1
    s_mov_b64 exec, -1
    s_waitcnt vmcnt(0)
    v_readfirstlane_b32 s68, v15
    v_readfirstlane_b32 s26, v14
    s_nop 1
    s_cmp_eq_u32 s68, s27
    s_cbranch_scc1 K2_SPINOK_44
    s_sub_u32 s67, s67, 1
    s_cbranch_scc1 K2_SPINOK_44
    s_sleep 16
    s_branch K2_SPIN_43
K2_SPINOK_44:
K2_AGD_35:
    s_mov_b64 exec, 1
    ds_write_b128 v47, v[12:15] offset:16
    s_mov_b64 exec, -1
    s_waitcnt lgkmcnt(0)
K2_S2_34:
    s_barrier
    ds_read_b128 v[12:15], v47 offset:16
    s_waitcnt lgkmcnt(0)
K2_SIDE_29:
    s_cmp_lt_u32 s3, 4
    s_cbranch_scc1 K2_A_31
    s_waitcnt vmcnt(24)
    v_readfirstlane_b32 s27, v12
    v_readfirstlane_b32 s68, v13
    s_nop 1
    s_lshr_b32 s27, s27, 18
    s_lshr_b32 s68, s68, 18
    s_min_u32 s69, s27, s68
    s_lshl_b32 s68, s68, 14
    s_or_b32 s27, s27, s68
    s_cmp_lg_u32 s69, 0
    s_cbranch_scc1 K2_TOK_45
    s_mov_b32 s67, 131072
K2_SPIN_46:
    s_lshr_b32 s68, s2, 3
    s_lshl_b32 s68, s68, 4
    s_and_b32 s69, s2, 1
    s_lshl_b32 s69, s69, 3
    s_add_u32 s68, s68, s69
    s_add_u32 s68, s68, 141312
    v_mov_b32 v41, 0
    s_mov_b64 exec, 1
    buffer_load_dwordx2 v[12:13], v41, s[48:51], 0 offen sc1
    s_mov_b64 exec, -1
    s_waitcnt vmcnt(0)
    v_readfirstlane_b32 s27, v12
    v_readfirstlane_b32 s68, v13
    s_nop 1
    s_lshr_b32 s27, s27, 18
    s_lshr_b32 s68, s68, 18
    s_min_u32 s69, s27, s68
    s_lshl_b32 s68, s68, 14
    s_or_b32 s27, s27, s68
    s_cmp_lg_u32 s69, 0
    s_cbranch_scc1 K2_SPINOK_47
    s_sub_u32 s67, s67, 1
    s_cbranch_scc1 K2_SPINOK_47
    s_sleep 8
    s_branch K2_SPIN_46
K2_SPINOK_47:
K2_TOK_45:
    v_readfirstlane_b32 s68, v15
    v_readfirstlane_b32 s26, v14
    s_nop 1
    s_cmp_eq_u32 s68, s27
    s_cbranch_scc1 K2_GOK_32
    s_mov_b32 s67, 131072
K2_SPIN_48:
    s_lshr_b32 s68, s2, 3
    s_lshl_b32 s68, s68, 4
    s_and_b32 s69, s2, 1
    s_lshl_b32 s69, s69, 3
    s_add_u32 s68, s68, s69
    s_add_u32 s68, s68, 141312
    v_mov_b32 v41, 0
    s_mov_b64 exec, 1
    buffer_load_dwordx2 v[14:15], v41, s[44:47], s68 offen sc1
    s_mov_b64 exec, -1
    s_waitcnt vmcnt(0)
    v_readfirstlane_b32 s68, v15
    v_readfirstlane_b32 s26, v14
    s_nop 1
    s_cmp_eq_u32 s68, s27
    s_cbranch_scc1 K2_SPINOK_49
    s_sub_u32 s67, s67, 1
    s_cbranch_scc1 K2_SPINOK_49
    s_sleep 8
    s_branch K2_SPIN_48
K2_SPINOK_49:
K2_GOK_32:
    s_mov_b32 s55, s26
    s_mov_b32 s54, 0
    s_bfe_u32 s53, s26, 0x60014
    s_and_b32 s26, s26, 0x3ffff
    s_min_u32 s26, s26, 160512
    s_lshl_b32 s66, s53, 11
    s_lshl_b32 s73, s52, 7
    s_add_u32 s66, s66, s73
    s_mul_i32 s68, s53, 2568192
    s_add_u32 s68, s68, 27262976
    s_add_u32 s40, s24, s68
    s_addc_u32 s41, s25, 0
    s_mov_b32 s42, 0
    s_mov_b32 s43, 0x20000
    s_lshl_b32 s42, s26, 4
    v_add_u32 v45, s54, v0
    v_subrev_u32 v45, 256, v45
    v_lshlrev_b32 v45, 4, v45
    s_movk_i32 s70, 0
    buffer_load_dwordx4 v[52:55], v45, s[40:43], s70 offen sc1
    s_movk_i32 s70, 4096
    buffer_load_dwordx4 v[56:59], v45, s[40:43], s70 offen sc1
    s_movk_i32 s70, 8192
    buffer_load_dwordx4 v[60:63], v45, s[40:43], s70 offen sc1
    s_movk_i32 s70, 12288
    buffer_load_dwordx4 v[64:67], v45, s[40:43], s70 offen sc1
    s_movk_i32 s70, 16384
    buffer_load_dwordx4 v[68:71], v45, s[40:43], s70 offen sc1
    s_movk_i32 s70, 20480
    buffer_load_dwordx4 v[72:75], v45, s[40:43], s70 offen sc1
    s_movk_i32 s70, 24576
    buffer_load_dwordx4 v[76:79], v45, s[40:43], s70 offen sc1
    s_movk_i32 s70, 28672
    buffer_load_dwordx4 v[80:83], v45, s[40:43], s70 offen sc1
    v_and_b32 v41, 63, v0
    v_lshlrev_b32 v46, 4, v41
    v_bfe_u32 v42, v0, 5, 3
    v_bfe_u32 v43, v0, 3, 2
    v_and_b32 v39, 7, v0
    v_lshlrev_b32 v39, 4, v39
    v_lshl_add_u32 v39, v43, 9, v39
    v_lshl_add_u32 v39, v42, 17, v39
    s_lshl_b32 s61, s77, 10
    s_movk_i32 s64, 640
    s_mov_b32 s65, 0xffff0000
    s_mov_b32 s54, 0
    v_mov_b32 v32, 0xff
    v_and_b32 v26, 7, v0
    v_bfe_u32 v27, v0, 3, 1
    v_lshlrev_b32 v26, 5, v26
    v_lshl_add_u32 v26, v27, 4, v26
    v_and_b32 v27, 15, v0
    v_lshlrev_b32 v27, 2, v27
    v_mul_u32_u24 v34, 255, v27
    v_bfe_u32 v33, v0, 4, 2
    v_lshlrev_b32 v33, 2, v33
    v_add_u32 v33, 157248, v33
    v_bfe_u32 v41, v0, 5, 1
    v_and_b32 v42, 1, v0
    v_cmp_eq_u32 vcc, v41, v42
    v_and_b32 v43, 16, v0
    v_mov_b32 v44, 32
    v_cndmask_b32 v28, 0, v44, vcc
    s_mul_i32 s73, s52, 6400000
    v_cndmask_b32 v29, 0, v43, vcc
    v_add_u32 v29, 119808, v29
    s_add_u32 s28, s24, s73
    s_addc_u32 s29, s25, 0
    s_mov_b32 s30, 6400000
    s_mov_b32 s31, 0x20000
    s_mov_b32 s36, s20
    s_mov_b32 s37, s21
    s_mov_b32 s38, 20480000
    s_mov_b32 s39, 0x20000
    v_sub_u32 v34, s66, v34
    v_mov_b32 v41, 160064
    v_mov_b32 v42, s55
    v_mov_b32 v43, s27
    ds_write_b64 v41, v[42:43]
    s_lshl_b32 s73, s77, 12
    v_add_u32 v47, s73, v46
    v_add_u32 v47, 136192, v47
    s_add_u32 s73, s73, 50176
    buffer_load_dwordx4 v[126:129], v46, s[44:47], s73 offen offset:0 sc1
    buffer_load_dwordx4 v[130:133], v46, s[44:47], s73 offen offset:1024 sc1
    buffer_load_dwordx4 v[134:137], v46, s[44:47], s73 offen offset:2048 sc1
    buffer_load_dwordx4 v[138:141], v46, s[44:47], s73 offen offset:3072 sc1
    s_waitcnt vmcnt(12) lgkmcnt(0)
    s_barrier
    s_cmp_lg_u32 s3, 4
    s_cbranch_scc1 K2_NOARR_50
    s_cmp_lt_u32 s2, 46
    s_cbranch_scc1 K2_NOARR_50
    s_mul_i32 s68, s2, 64
    s_add_u32 s68, s68, 108544
    v_mbcnt_lo_u32_b32 v41, -1, 0
    v_mov_b32 v43, s27
    v_lshlrev_b32 v41, 2, v41
    s_mov_b64 exec, 0xffff
    buffer_store_dword v43, v41, s[44:47], s68 offen sc1
    s_mov_b64 exec, -1
K2_NOARR_50:
    s_add_u32 m0, s61, 0
    s_add_u32 s75, s66, 0
    buffer_load_dwordx4 v39, s[32:35], s75 offen lds
    s_add_u32 m0, s61, 4096
    s_add_u32 s75, s66, 1048576
    buffer_load_dwordx4 v39, s[32:35], s75 offen lds
    s_waitcnt vmcnt(2)
    ds_write_b128 v47, v[126:129] offset:0
    ds_write_b128 v47, v[130:133] offset:1024
    ds_write_b128 v47, v[134:137] offset:2048
    ds_write_b128 v47, v[138:141] offset:3072
    s_mul_i32 s74, s52, 6144
    s_add_u32 s74, s74, 83968
    s_add_u32 s75, s74, 3072
    buffer_load_dwordx4 v[2:5], v46, s[44:47], s74 offen offset:0 sc1
    buffer_load_dwordx4 v[6:9], v46, s[44:47], s74 offen offset:1024 sc1
    buffer_load_dwordx4 v[10:13], v46, s[44:47], s74 offen offset:2048 sc1
    buffer_load_dwordx4 v[14:17], v46, s[44:47], s75 offen offset:0 sc1
    buffer_load_dwordx4 v[18:21], v46, s[44:47], s75 offen offset:1024 sc1
    buffer_load_dwordx4 v[22:25], v46, s[44:47], s75 offen offset:2048 sc1
K2_RANK_27:
    s_waitcnt lgkmcnt(0)
    v_mov_b32 v44, 1
    v_mov_b32 v50, 157184
    s_sub_u32 s70, s26, s54
    s_add_u32 s70, s70, 256
    v_add_u32 v45, 0, v0
    v_and_b32 v46, 1, v32
    v_cmp_gt_u32 vcc, s70, v45
    v_cmp_ne_u32 s[68:69], 0, v46
    v_and_b32 v92, 0x1ff, v52
    v_mov_b32 v84, 65536
    s_and_b64 s[68:69], vcc, s[68:69]
    v_cmp_gt_u32 vcc, 320, v92
    v_lshlrev_b32 v92, 2, v92
    v_add_u32 v92, 155648, v92
    v_mov_b32 v110, 0
    s_and_b64 s[68:69], vcc, s[68:69]
    v_cmp_gt_i32 vcc, 0, v55
    v_and_b32 v52, s65, v52
    s_and_b64 exec, vcc, s[68:69]
    s_cbranch_execz K2_NORARE_51
    ds_add_rtn_u32 v48, v50, v44 offset:8
    v_bfe_u32 v47, v55, 16, 15
    v_lshlrev_b32 v47, 5, v47
    buffer_load_dwordx4 v[142:145], v47, s[44:47], 0 offen sc1
    buffer_load_dwordx4 v[146:149], v47, s[44:47], 0 offen offset:16 sc1
    v_and_b32 v55, 0xffff, v55
    v_mov_b32 v84, 65535
    s_waitcnt lgkmcnt(0)
    v_add_u32 v48, 1, v48
    v_cmp_le_u32 vcc, 512, v48
    v_lshl_or_b32 v55, v48, 16, v55
    v_lshlrev_b32 v48, 5, v48
    s_andn2_b64 s[68:69], s[68:69], vcc
    s_andn2_b64 exec, exec, vcc
    v_add_u32 v110, 119808, v48
K2_NORARE_51:
    s_mov_b64 exec, s[68:69]
    ds_add_rtn_u32 v84, v92, v44
    s_mov_b64 exec, -1
    v_add_u32 v45, 256, v0
    v_and_b32 v46, 2, v32
    v_cmp_gt_u32 vcc, s70, v45
    v_cmp_ne_u32 s[68:69], 0, v46
    v_and_b32 v93, 0x1ff, v56
    v_mov_b32 v85, 65536
    s_and_b64 s[68:69], vcc, s[68:69]
    v_cmp_gt_u32 vcc, 320, v93
    v_lshlrev_b32 v93, 2, v93
    v_add_u32 v93, 155648, v93
    v_mov_b32 v111, 0
    s_and_b64 s[68:69], vcc, s[68:69]
    v_cmp_gt_i32 vcc, 0, v59
    v_and_b32 v56, s65, v56
    s_and_b64 exec, vcc, s[68:69]
    s_cbranch_execz K2_NORARE_52
    ds_add_rtn_u32 v48, v50, v44 offset:8
    v_bfe_u32 v47, v59, 16, 15
    v_lshlrev_b32 v47, 5, v47
    buffer_load_dwordx4 v[150:153], v47, s[44:47], 0 offen sc1
    buffer_load_dwordx4 v[154:157], v47, s[44:47], 0 offen offset:16 sc1
    v_and_b32 v59, 0xffff, v59
    v_mov_b32 v85, 65535
    s_waitcnt lgkmcnt(0)
    v_add_u32 v48, 1, v48
    v_cmp_le_u32 vcc, 512, v48
    v_lshl_or_b32 v59, v48, 16, v59
    v_lshlrev_b32 v48, 5, v48
    s_andn2_b64 s[68:69], s[68:69], vcc
    s_andn2_b64 exec, exec, vcc
    v_add_u32 v111, 119808, v48
K2_NORARE_52:
    s_mov_b64 exec, s[68:69]
    ds_add_rtn_u32 v85, v93, v44
    s_mov_b64 exec, -1
    v_add_u32 v45, 512, v0
    v_and_b32 v46, 4, v32
    v_cmp_gt_u32 vcc, s70, v45
    v_cmp_ne_u32 s[68:69], 0, v46
    v_and_b32 v94, 0x1ff, v60
    v_mov_b32 v86, 65536
    s_and_b64 s[68:69], vcc, s[68:69]
    v_cmp_gt_u32 vcc, 320, v94
    v_lshlrev_b32 v94, 2, v94
    v_add_u32 v94, 155648, v94
    v_mov_b32 v112, 0
    s_and_b64 s[68:69], vcc, s[68:69]
    v_cmp_gt_i32 vcc, 0, v63
    v_and_b32 v60, s65, v60
    s_and_b64 exec, vcc, s[68:69]
    s_cbranch_execz K2_NORARE_53
    ds_add_rtn_u32 v48, v50, v44 offset:8
    v_bfe_u32 v47, v63, 16, 15
    v_lshlrev_b32 v47, 5, v47
    buffer_load_dwordx4 v[158:161], v47, s[44:47], 0 offen sc1
    buffer_load_dwordx4 v[162:165], v47, s[44:47], 0 offen offset:16 sc1
    v_and_b32 v63, 0xffff, v63
    v_mov_b32 v86, 65535
    s_waitcnt lgkmcnt(0)
    v_add_u32 v48, 1, v48
    v_cmp_le_u32 vcc, 512, v48
    v_lshl_or_b32 v63, v48, 16, v63
    v_lshlrev_b32 v48, 5, v48
    s_andn2_b64 s[68:69], s[68:69], vcc
    s_andn2_b64 exec, exec, vcc
    v_add_u32 v112, 119808, v48
K2_NORARE_53:
    s_mov_b64 exec, s[68:69]
    ds_add_rtn_u32 v86, v94, v44
    s_mov_b64 exec, -1
    v_add_u32 v45, 768, v0
    v_and_b32 v46, 8, v32
    v_cmp_gt_u32 vcc, s70, v45
    v_cmp_ne_u32 s[68:69], 0, v46
    v_and_b32 v95, 0x1ff, v64
    v_mov_b32 v87, 65536
    s_and_b64 s[68:69], vcc, s[68:69]
    v_cmp_gt_u32 vcc, 320, v95
    v_lshlrev_b32 v95, 2, v95
    v_add_u32 v95, 155648, v95
    v_mov_b32 v113, 0
    s_and_b64 s[68:69], vcc, s[68:69]
    v_cmp_gt_i32 vcc, 0, v67
    v_and_b32 v64, s65, v64
    s_and_b64 exec, vcc, s[68:69]
    s_cbranch_execz K2_NORARE_54
    ds_add_rtn_u32 v48, v50, v44 offset:8
    v_bfe_u32 v47, v67, 16, 15
    v_lshlrev_b32 v47, 5, v47
    buffer_load_dwordx4 v[166:169], v47, s[44:47], 0 offen sc1
    buffer_load_dwordx4 v[170:173], v47, s[44:47], 0 offen offset:16 sc1
    v_and_b32 v67, 0xffff, v67
    v_mov_b32 v87, 65535
    s_waitcnt lgkmcnt(0)
    v_add_u32 v48, 1, v48
    v_cmp_le_u32 vcc, 512, v48
    v_lshl_or_b32 v67, v48, 16, v67
    v_lshlrev_b32 v48, 5, v48
    s_andn2_b64 s[68:69], s[68:69], vcc
    s_andn2_b64 exec, exec, vcc
    v_add_u32 v113, 119808, v48
K2_NORARE_54:
    s_mov_b64 exec, s[68:69]
    ds_add_rtn_u32 v87, v95, v44
    s_mov_b64 exec, -1
    v_add_u32 v45, 1024, v0
    v_and_b32 v46, 16, v32
    v_cmp_gt_u32 vcc, s70, v45
    v_cmp_ne_u32 s[68:69], 0, v46
    v_and_b32 v96, 0x1ff, v68
    v_mov_b32 v88, 65536
    s_and_b64 s[68:69], vcc, s[68:69]
    v_cmp_gt_u32 vcc, 320, v96
    v_lshlrev_b32 v96, 2, v96
    v_add_u32 v96, 155648, v96
    v_mov_b32 v114, 0
    s_and_b64 s[68:69], vcc, s[68:69]
    v_cmp_gt_i32 vcc, 0, v71
    v_and_b32 v68, s65, v68
    s_and_b64 exec, vcc, s[68:69]
    s_cbranch_execz K2_NORARE_55
    ds_add_rtn_u32 v48, v50, v44 offset:8
    v_bfe_u32 v47, v71, 16, 15
    v_lshlrev_b32 v47, 5, v47
    buffer_load_dwordx4 v[174:177], v47, s[44:47], 0 offen sc1
    buffer_load_dwordx4 v[178:181], v47, s[44:47], 0 offen offset:16 sc1
    v_and_b32 v71, 0xffff, v71
    v_mov_b32 v88, 65535
    s_waitcnt lgkmcnt(0)
    v_add_u32 v48, 1, v48
    v_cmp_le_u32 vcc, 512, v48
    v_lshl_or_b32 v71, v48, 16, v71
    v_lshlrev_b32 v48, 5, v48
    s_andn2_b64 s[68:69], s[68:69], vcc
    s_andn2_b64 exec, exec, vcc
    v_add_u32 v114, 119808, v48
K2_NORARE_55:
    s_mov_b64 exec, s[68:69]
    ds_add_rtn_u32 v88, v96, v44
    s_mov_b64 exec, -1
    v_add_u32 v45, 1280, v0
    v_and_b32 v46, 32, v32
    v_cmp_gt_u32 vcc, s70, v45
    v_cmp_ne_u32 s[68:69], 0, v46
    v_and_b32 v97, 0x1ff, v72
    v_mov_b32 v89, 65536
    s_and_b64 s[68:69], vcc, s[68:69]
    v_cmp_gt_u32 vcc, 320, v97
    v_lshlrev_b32 v97, 2, v97
    v_add_u32 v97, 155648, v97
    v_mov_b32 v115, 0
    s_and_b64 s[68:69], vcc, s[68:69]
    v_cmp_gt_i32 vcc, 0, v75
    v_and_b32 v72, s65, v72
    s_and_b64 exec, vcc, s[68:69]
    s_cbranch_execz K2_NORARE_56
    ds_add_rtn_u32 v48, v50, v44 offset:8
    v_bfe_u32 v47, v75, 16, 15
    v_lshlrev_b32 v47, 5, v47
    buffer_load_dwordx4 v[182:185], v47, s[44:47], 0 offen sc1
    buffer_load_dwordx4 v[186:189], v47, s[44:47], 0 offen offset:16 sc1
    v_and_b32 v75, 0xffff, v75
    v_mov_b32 v89, 65535
    s_waitcnt lgkmcnt(0)
    v_add_u32 v48, 1, v48
    v_cmp_le_u32 vcc, 512, v48
    v_lshl_or_b32 v75, v48, 16, v75
    v_lshlrev_b32 v48, 5, v48
    s_andn2_b64 s[68:69], s[68:69], vcc
    s_andn2_b64 exec, exec, vcc
    v_add_u32 v115, 119808, v48
K2_NORARE_56:
    s_mov_b64 exec, s[68:69]
    ds_add_rtn_u32 v89, v97, v44
    s_mov_b64 exec, -1
    v_add_u32 v45, 1536, v0
    v_and_b32 v46, 64, v32
    v_cmp_gt_u32 vcc, s70, v45
    v_cmp_ne_u32 s[68:69], 0, v46
    v_and_b32 v98, 0x1ff, v76
    v_mov_b32 v90, 65536
    s_and_b64 s[68:69], vcc, s[68:69]
    v_cmp_gt_u32 vcc, 320, v98
    v_lshlrev_b32 v98, 2, v98
    v_add_u32 v98, 155648, v98
    v_mov_b32 v116, 0
    s_and_b64 s[68:69], vcc, s[68:69]
    v_cmp_gt_i32 vcc, 0, v79
    v_and_b32 v76, s65, v76
    s_and_b64 exec, vcc, s[68:69]
    s_cbranch_execz K2_NORARE_57
    ds_add_rtn_u32 v48, v50, v44 offset:8
    v_bfe_u32 v47, v79, 16, 15
    v_lshlrev_b32 v47, 5, v47
    buffer_load_dwordx4 v[190:193], v47, s[44:47], 0 offen sc1
    buffer_load_dwordx4 v[194:197], v47, s[44:47], 0 offen offset:16 sc1
    v_and_b32 v79, 0xffff, v79
    v_mov_b32 v90, 65535
    s_waitcnt lgkmcnt(0)
    v_add_u32 v48, 1, v48
    v_cmp_le_u32 vcc, 512, v48
    v_lshl_or_b32 v79, v48, 16, v79
    v_lshlrev_b32 v48, 5, v48
    s_andn2_b64 s[68:69], s[68:69], vcc
    s_andn2_b64 exec, exec, vcc
    v_add_u32 v116, 119808, v48
K2_NORARE_57:
    s_mov_b64 exec, s[68:69]
    ds_add_rtn_u32 v90, v98, v44
    s_mov_b64 exec, -1
    v_add_u32 v45, 1792, v0
    v_and_b32 v46, 128, v32
    v_cmp_gt_u32 vcc, s70, v45
    v_cmp_ne_u32 s[68:69], 0, v46
    v_and_b32 v99, 0x1ff, v80
    v_mov_b32 v91, 65536
    s_and_b64 s[68:69], vcc, s[68:69]
    v_cmp_gt_u32 vcc, 320, v99
    v_lshlrev_b32 v99, 2, v99
    v_add_u32 v99, 155648, v99
    v_mov_b32 v117, 0
    s_and_b64 s[68:69], vcc, s[68:69]
    v_cmp_gt_i32 vcc, 0, v83
    v_and_b32 v80, s65, v80
    s_and_b64 exec, vcc, s[68:69]
    s_cbranch_execz K2_NORARE_58
    ds_add_rtn_u32 v48, v50, v44 offset:8
    v_bfe_u32 v47, v83, 16, 15
    v_lshlrev_b32 v47, 5, v47
    buffer_load_dwordx4 v[198:201], v47, s[44:47], 0 offen sc1
    buffer_load_dwordx4 v[202:205], v47, s[44:47], 0 offen offset:16 sc1
    v_and_b32 v83, 0xffff, v83
    v_mov_b32 v91, 65535
    s_waitcnt lgkmcnt(0)
    v_add_u32 v48, 1, v48
    v_cmp_le_u32 vcc, 512, v48
    v_lshl_or_b32 v83, v48, 16, v83
    v_lshlrev_b32 v48, 5, v48
    s_andn2_b64 s[68:69], s[68:69], vcc
    s_andn2_b64 exec, exec, vcc
    v_add_u32 v117, 119808, v48
K2_NORARE_58:
    s_mov_b64 exec, s[68:69]
    ds_add_rtn_u32 v91, v99, v44
    s_mov_b64 exec, -1
    s_cmp_eq_u32 s76, 0
    s_cbranch_scc1 K2_NP1_59
    s_add_u32 m0, s61, 8192
    s_add_u32 s75, s66, 2097152
    buffer_load_dwordx4 v39, s[32:35], s75 offen lds
    s_add_u32 m0, s61, 12288
    s_add_u32 s75, s66, 3145728
    buffer_load_dwordx4 v39, s[32:35], s75 offen lds
K2_NP1_59:
    s_waitcnt lgkmcnt(0)
    s_barrier
    s_branch K2_X_28
K2_A_31:
    v_and_b32 v41, 63, v0
    v_lshlrev_b32 v46, 4, v41
    v_bfe_u32 v42, v0, 5, 3
    v_bfe_u32 v43, v0, 3, 2
    v_and_b32 v39, 7, v0
    v_lshlrev_b32 v39, 4, v39
    v_lshl_add_u32 v39, v43, 9, v39
    v_lshl_add_u32 v39, v42, 17, v39
    s_lshl_b32 s61, s77, 10
    s_movk_i32 s64, 640
    s_mov_b32 s65, 0xffff0000
    s_mov_b32 s54, 0
    v_mov_b32 v32, 0xff
    v_and_b32 v26, 7, v0
    v_bfe_u32 v27, v0, 3, 1
    v_lshlrev_b32 v26, 5, v26
    v_lshl_add_u32 v26, v27, 4, v26
    v_and_b32 v27, 15, v0
    v_lshlrev_b32 v27, 2, v27
    v_mul_u32_u24 v34, 255, v27
    v_bfe_u32 v33, v0, 4, 2
    v_lshlrev_b32 v33, 2, v33
    v_add_u32 v33, 157248, v33
    v_bfe_u32 v41, v0, 5, 1
    v_and_b32 v42, 1, v0
    v_cmp_eq_u32 vcc, v41, v42
    v_and_b32 v43, 16, v0
    v_mov_b32 v44, 32
    v_cndmask_b32 v28, 0, v44, vcc
    s_mul_i32 s73, s52, 6400000
    v_cndmask_b32 v29, 0, v43, vcc
    v_add_u32 v29, 119808, v29
    s_add_u32 s28, s24, s73
    s_addc_u32 s29, s25, 0
    s_mov_b32 s30, 6400000
    s_mov_b32 s31, 0x20000
    s_mov_b32 s36, s20
    s_mov_b32 s37, s21
    s_mov_b32 s38, 20480000
    s_mov_b32 s39, 0x20000
    v_mov_b32 v47, 160064
    s_waitcnt vmcnt(0)
    s_barrier
    ds_read_b64 v[42:43], v47
    s_waitcnt lgkmcnt(0)
    v_readfirstlane_b32 s26, v42
    v_readfirstlane_b32 s27, v43
    s_nop 1
    s_bfe_u32 s53, s26, 0x60014
    s_and_b32 s26, s26, 0x3ffff
    s_min_u32 s26, s26, 160512
    s_lshl_b32 s66, s53, 11
    s_lshl_b32 s73, s52, 7
    s_add_u32 s66, s66, s73
    v_sub_u32 v34, s66, v34
    s_add_u32 s40, s24, 27262976
    s_addc_u32 s41, s25, 0
    s_mov_b32 s42, 0
    s_mov_b32 s43, 0x20000
    v_mov_b32 v48, 0
    v_mov_b32 v49, 0
    v_mov_b32 v50, 0
    v_mov_b32 v51, 0xffff
    v_lshlrev_b32 v44, 4, v0
    v_add_u32 v44, 81920, v44
    ds_write_b128 v44, v[48:51] offset:0
    ds_write_b128 v44, v[48:51] offset:4096
    ds_write_b128 v44, v[48:51] offset:8192
    ds_write_b128 v44, v[48:51] offset:12288
    ds_write_b128 v44, v[48:51] offset:16384
    ds_write_b128 v44, v[48:51] offset:20480
    ds_write_b128 v44, v[48:51] offset:24576
    ds_write_b128 v44, v[48:51] offset:28672
    ds_write_b128 v44, v[48:51] offset:32768
    v_cmp_gt_u32 vcc, 64, v0
    s_and_b64 exec, exec, vcc
    ds_write_b128 v44, v[48:51] offset:36864
    s_mov_b64 exec, -1
    v_lshlrev_b32 v44, 3, v0
    v_add_u32 v44, 119808, v44
    v_cmp_gt_u32 vcc, 4, v0
    s_and_b64 exec, exec, vcc
    ds_write_b64 v44, v[48:49]
    s_mov_b64 exec, -1
    s_add_u32 m0, s61, 32768
    s_add_u32 s75, s66, 8388608
    buffer_load_dwordx4 v39, s[32:35], s75 offen lds
    s_add_u32 m0, s61, 36864
    s_add_u32 s75, s66, 9437184
    buffer_load_dwordx4 v39, s[32:35], s75 offen lds
    s_add_u32 m0, s61, 40960
    s_add_u32 s75, s66, 10485760
    buffer_load_dwordx4 v39, s[32:35], s75 offen lds
    s_add_u32 m0, s61, 45056
    s_add_u32 s75, s66, 11534336
    buffer_load_dwordx4 v39, s[32:35], s75 offen lds
    s_add_u32 m0, s61, 49152
    s_add_u32 s75, s66, 12582912
    buffer_load_dwordx4 v39, s[32:35], s75 offen lds
    s_add_u32 m0, s61, 53248
    s_add_u32 s75, s66, 13631488
    buffer_load_dwordx4 v39, s[32:35], s75 offen lds
    s_mul_i32 s74, s52, 6144
    s_add_u32 s74, s74, 83968
    s_add_u32 s75, s74, 3072
    buffer_load_dwordx4 v[2:5], v46, s[44:47], s74 offen offset:0 sc1
    buffer_load_dwordx4 v[6:9], v46, s[44:47], s74 offen offset:1024 sc1
    buffer_load_dwordx4 v[10:13], v46, s[44:47], s74 offen offset:2048 sc1
    buffer_load_dwordx4 v[14:17], v46, s[44:47], s75 offen offset:0 sc1
    buffer_load_dwordx4 v[18:21], v46, s[44:47], s75 offen offset:1024 sc1
    buffer_load_dwordx4 v[22:25], v46, s[44:47], s75 offen offset:2048 sc1
    s_waitcnt lgkmcnt(0)
    s_barrier
K2_X_28:
    v_mov_b32 v44, 1
    v_mov_b32 v50, 157184
    s_cmp_ge_u32 s3, 5
    s_cbranch_scc1 K2_P7_60
    v_lshlrev_b32 v48, 2, v0
    v_add_u32 v48, 155648, v48
    ds_read_b32 v45, v48
    v_cmp_le_u32 vcc, 160, v0
    v_mov_b32 v51, 31
    v_mov_b32 v49, 63
    v_cndmask_b32 v51, v51, v49, vcc
    s_waitcnt lgkmcnt(0)
    v_min_u32 v45, 30, v45
    v_sub_u32 v51, v51, v45
    v_lshlrev_b32 v51, 2, v51
    v_add_u32 v48, 156928, v51
    ds_add_rtn_u32 v46, v48, v44
    s_waitcnt lgkmcnt(0)
K2_P7_60:
    s_cmp_eq_u32 s76, 0
    s_cbranch_scc1 K2_NOPARK_62
    s_cmp_ge_u32 s3, 4
    s_cbranch_scc1 K2_PARKB_63
    s_add_u32 m0, s61, 57344
    s_add_u32 s75, s66, 14680064
    buffer_load_dwordx4 v39, s[32:35], s75 offen lds
    s_branch K2_NOPARK_62
K2_PARKB_63:
    s_add_u32 m0, s61, 16384
    s_add_u32 s75, s66, 4194304
    buffer_load_dwordx4 v39, s[32:35], s75 offen lds
    s_add_u32 m0, s61, 20480
    s_add_u32 s75, s66, 5242880
    buffer_load_dwordx4 v39, s[32:35], s75 offen lds
    s_add_u32 m0, s61, 24576
    s_add_u32 s75, s66, 6291456
    buffer_load_dwordx4 v39, s[32:35], s75 offen lds
K2_NOPARK_62:
    s_barrier
    s_cmp_ge_u32 s3, 5
    s_cbranch_scc1 K2_P8_61
    v_and_b32 v48, 63, v0
    v_lshlrev_b32 v48, 2, v48
    v_add_u32 v48, 156928, v48
    ds_read_b32 v47, v48
    v_subrev_u32 v48, 160, v0
    v_min_u32 v48, v48, v0
    v_lshl_or_b32 v45, v45, 16, v48
    s_waitcnt lgkmcnt(0)
    v_mov_b32 v49, v47
    s_nop 1
    v_add_u32_dpp v47, v47, v47 row_shr:1 row_mask:0xf bank_mask:0xf bound_ctrl:0
    s_nop 1
    v_add_u32_dpp v47, v47, v47 row_shr:2 row_mask:0xf bank_mask:0xf bound_ctrl:0
    s_nop 1
    v_add_u32_dpp v47, v47, v47 row_shr:4 row_mask:0xf bank_mask:0xf bound_ctrl:0
    s_nop 1
    v_add_u32_dpp v47, v47, v47 row_shr:8 row_mask:0xf bank_mask:0xf bound_ctrl:0
    s_nop 1
    v_add_u32_dpp v47, v47, v47 row_bcast:15 row_mask:0xa bank_mask:0xf
    s_nop 1
    v_add_u32_dpp v47, v47, v47 row_bcast:31 row_mask:0xc bank_mask:0xf
    v_sub_u32 v47, v47, v49
    ds_bpermute_b32 v49, v51, v47
    s_waitcnt lgkmcnt(0)
    v_add_lshl_u32 v49, v49, v46, 2
    v_add_u32 v49, 157248, v49
    ds_write_b32 v49, v45
    s_waitcnt lgkmcnt(0)
K2_P8_61:
    s_cmp_eq_u32 s76, 0
    s_cbranch_scc1 K2_NOPARK_64
    s_cmp_ge_u32 s3, 4
    s_cbranch_scc1 K2_PARKB_65
    s_add_u32 m0, s61, 61440
    s_add_u32 s75, s66, 15728640
    buffer_load_dwordx4 v39, s[32:35], s75 offen lds
    s_branch K2_NOPARK_64
K2_PARKB_65:
    s_add_u32 m0, s61, 28672
    s_add_u32 s75, s66, 7340032
    buffer_load_dwordx4 v39, s[32:35], s75 offen lds
    s_add_u32 m0, s61, 65536
    s_add_u32 s75, s66, 16777216
    buffer_load_dwordx4 v39, s[32:35], s75 offen lds
    s_add_u32 m0, s61, 69632
    s_add_u32 s75, s66, 17825792
    buffer_load_dwordx4 v39, s[32:35], s75 offen lds
K2_NOPARK_64:
    s_barrier
    s_lshl_b32 s58, s3, 4
    s_xor_b32 s69, s58, 112
    v_add_u32 v46, s58, v33
    v_add_u32 v47, s69, v33
    ds_read_b32 v100, v46 offset:0
    ds_read_b32 v101, v47 offset:128
    ds_read_b32 v102, v46 offset:256
    ds_read_b32 v103, v47 offset:384
    ds_read_b32 v104, v47 offset:512
    ds_read_b32 v105, v46 offset:640
    ds_read_b32 v106, v47 offset:768
    ds_read_b32 v107, v46 offset:896
    ds_read_b32 v108, v47 offset:1024
    ds_read_b32 v109, v47 offset:1152
    s_waitcnt lgkmcnt(0)
    v_readfirstlane_b32 s8, v100
    v_readfirstlane_b32 s9, v101
    v_readfirstlane_b32 s10, v102
    v_readfirstlane_b32 s11, v103
    v_readfirstlane_b32 s12, v104
    v_readfirstlane_b32 s13, v105
    v_readfirstlane_b32 s14, v106
    v_readfirstlane_b32 s15, v107
    v_readfirstlane_b32 s16, v108
    v_readfirstlane_b32 s17, v109
    v_mov_b32 v35, v100
    s_mov_b32 s59, 858
    s_mov_b64 s[56:57], 0
    s_mov_b32 s55, 0
    s_lshr_b32 s68, s8, 16
    s_mov_b32 s8, s55
    s_add_u32 s55, s55, s68
    s_lshl_b32 s68, s68, 0
    s_or_b32 s56, s56, s68
    s_lshr_b32 s68, s9, 16
    s_mov_b32 s9, s55
    s_add_u32 s55, s55, s68
    s_lshl_b32 s68, s68, 5
    s_or_b32 s56, s56, s68
    s_lshr_b32 s68, s10, 16
    s_mov_b32 s10, s55
    s_add_u32 s55, s55, s68
    s_lshl_b32 s68, s68, 10
    s_or_b32 s56, s56, s68
    s_lshr_b32 s68, s11, 16
    s_mov_b32 s11, s55
    s_add_u32 s55, s55, s68
    s_lshl_b32 s68, s68, 15
    s_or_b32 s56, s56, s68
    s_lshr_b32 s68, s12, 16
    s_mov_b32 s12, s55
    s_add_u32 s55, s55, s68
    s_lshl_b32 s68, s68, 20
    s_or_b32 s56, s56, s68
    s_lshr_b32 s68, s13, 16
    s_mov_b32 s13, s55
    s_add_u32 s55, s55, s68
    s_lshl_b32 s68, s68, 0
    s_or_b32 s57, s57, s68
    s_lshr_b32 s68, s14, 16
    s_mov_b32 s14, s55
    s_add_u32 s55, s55, s68
    s_lshl_b32 s68, s68, 5
    s_or_b32 s57, s57, s68
    s_lshr_b32 s68, s15, 16
    s_mov_b32 s15, s55
    s_add_u32 s55, s55, s68
    s_lshl_b32 s68, s68, 10
    s_or_b32 s57, s57, s68
    s_lshr_b32 s68, s16, 16
    s_mov_b32 s16, s55
    s_add_u32 s55, s55, s68
    s_lshl_b32 s68, s68, 15
    s_or_b32 s57, s57, s68
    s_lshr_b32 s68, s17, 16
    s_mov_b32 s17, s55
    s_add_u32 s55, s55, s68
    s_lshl_b32 s68, s68, 20
    s_or_b32 s57, s57, s68
    s_add_u32 s55, s55, 1
    s_lshr_b32 s55, s55, 1
    v_mov_b32 v48, s55
    s_mov_b64 exec, 1
    ds_add_rtn_u32 v49, v50, v48
    s_mov_b64 exec, -1
    v_and_b32 v100, 0xff, v100
    v_lshlrev_b32 v100, 2, v100
    v_add_u32 v100, 158784, v100
    v_and_b32 v101, 0xff, v101
    v_lshlrev_b32 v101, 2, v101
    v_add_u32 v101, 158784, v101
    v_and_b32 v102, 0xff, v102
    v_lshlrev_b32 v102, 2, v102
    v_add_u32 v102, 158784, v102
    v_and_b32 v103, 0xff, v103
    v_lshlrev_b32 v103, 2, v103
    v_add_u32 v103, 158784, v103
    v_and_b32 v104, 0xff, v104
    v_lshlrev_b32 v104, 2, v104
    v_add_u32 v104, 158784, v104
    v_and_b32 v105, 0xff, v105
    v_lshlrev_b32 v105, 2, v105
    v_add_u32 v105, 159424, v105
    v_and_b32 v106, 0xff, v106
    v_lshlrev_b32 v106, 2, v106
    v_add_u32 v106, 159424, v106
    v_and_b32 v107, 0xff, v107
    v_lshlrev_b32 v107, 2, v107
    v_add_u32 v107, 159424, v107
    v_and_b32 v108, 0xff, v108
    v_lshlrev_b32 v108, 2, v108
    v_add_u32 v108, 159424, v108
    v_and_b32 v109, 0xff, v109
    v_lshlrev_b32 v109, 2, v109
    v_add_u32 v109, 159424, v109
    v_bfe_u32 v45, v0, 4, 2
    v_bfe_u32 v46, v0, 1, 1
    v_bfe_u32 v47, v0, 2, 2
    v_lshlrev_b32 v46, 6, v46
    v_lshl_add_u32 v46, v47, 4, v46
    s_waitcnt lgkmcnt(0)
    v_readfirstlane_b32 s68, v49
    s_nop 1
    s_lshl_b32 s68, s68, 7
    s_add_u32 s68, s68, 81920
    v_lshl_add_u32 v30, v45, 4, s68
    v_add_u32 v31, s68, v46
    v_lshl_add_u32 v47, s8, 6, v30
    ds_write_b32 v100, v47
    v_lshl_add_u32 v48, s9, 6, v30
    ds_write_b32 v101, v48
    v_lshl_add_u32 v47, s10, 6, v30
    ds_write_b32 v102, v47
    v_lshl_add_u32 v48, s11, 6, v30
    ds_write_b32 v103, v48
    v_lshl_add_u32 v47, s12, 6, v30
    ds_write_b32 v104, v47
    v_lshl_add_u32 v48, s13, 6, v30
    ds_write_b32 v105, v48
    v_lshl_add_u32 v47, s14, 6, v30
    ds_write_b32 v106, v47
    v_lshl_add_u32 v48, s15, 6, v30
    ds_write_b32 v107, v48
    v_lshl_add_u32 v47, s16, 6, v30
    ds_write_b32 v108, v47
    v_lshl_add_u32 v48, s17, 6, v30
    ds_write_b32 v109, v48
    s_cmp_eq_u32 s76, 0
    s_cbranch_scc1 K2_NOPARK_66
    s_cmp_ge_u32 s3, 4
    s_cbranch_scc1 K2_PARKB_67
    s_branch K2_NOPARK_66
K2_PARKB_67:
    s_add_u32 m0, s61, 73728
    s_add_u32 s75, s66, 18874368
    buffer_load_dwordx4 v39, s[32:35], s75 offen lds
    s_add_u32 m0, s61, 77824
    s_add_u32 s75, s66, 19922944
    buffer_load_dwordx4 v39, s[32:35], s75 offen lds
K2_NOPARK_66:
    s_waitcnt lgkmcnt(0)
    s_barrier
    s_cmp_lt_u32 s3, 4
    s_cbranch_scc1 K2_SCA_68
    ds_read_b32 v118, v92 offset:3136
    ds_read_b32 v119, v93 offset:3136
    ds_read_b32 v120, v94 offset:3136
    ds_read_b32 v121, v95 offset:3136
    ds_read_b32 v122, v96 offset:3136
    ds_read_b32 v123, v97 offset:3136
    ds_read_b32 v124, v98 offset:3136
    ds_read_b32 v125, v99 offset:3136
    v_mov_b32 v32, 0
    s_mov_b32 s70, 65536
    v_cmp_gt_u32 vcc, 30, v84
    v_cmp_gt_u32 s[68:69], s70, v84
    s_waitcnt lgkmcnt(0)
    v_lshl_add_u32 v118, v84, 6, v118
    s_mov_b64 exec, vcc
    ds_write_b128 v118, v[52:55]
    s_andn2_b64 exec, s[68:69], vcc
    s_cbranch_execz K2_NOPEND_70
    v_or_b32 v32, 1, v32
    ds_write_b32 v50, v44 offset:4
K2_NOPEND_70:
    s_mov_b64 exec, -1
    v_cmp_gt_u32 vcc, 30, v85
    v_cmp_gt_u32 s[68:69], s70, v85
    v_lshl_add_u32 v119, v85, 6, v119
    s_mov_b64 exec, vcc
    ds_write_b128 v119, v[56:59]
    s_andn2_b64 exec, s[68:69], vcc
    s_cbranch_execz K2_NOPEND_71
    v_or_b32 v32, 2, v32
    ds_write_b32 v50, v44 offset:4
K2_NOPEND_71:
    s_mov_b64 exec, -1
    v_cmp_gt_u32 vcc, 30, v86
    v_cmp_gt_u32 s[68:69], s70, v86
    v_lshl_add_u32 v120, v86, 6, v120
    s_mov_b64 exec, vcc
    ds_write_b128 v120, v[60:63]
    s_andn2_b64 exec, s[68:69], vcc
    s_cbranch_execz K2_NOPEND_72
    v_or_b32 v32, 4, v32
    ds_write_b32 v50, v44 offset:4
K2_NOPEND_72:
    s_mov_b64 exec, -1
    v_cmp_gt_u32 vcc, 30, v87
    v_cmp_gt_u32 s[68:69], s70, v87
    v_lshl_add_u32 v121, v87, 6, v121
    s_mov_b64 exec, vcc
    ds_write_b128 v121, v[64:67]
    s_andn2_b64 exec, s[68:69], vcc
    s_cbranch_execz K2_NOPEND_73
    v_or_b32 v32, 8, v32
    ds_write_b32 v50, v44 offset:4
K2_NOPEND_73:
    s_mov_b64 exec, -1
    v_cmp_gt_u32 vcc, 30, v88
    v_cmp_gt_u32 s[68:69], s70, v88
    v_lshl_add_u32 v122, v88, 6, v122
    s_mov_b64 exec, vcc
    ds_write_b128 v122, v[68:71]
    s_andn2_b64 exec, s[68:69], vcc
    s_cbranch_execz K2_NOPEND_74
    v_or_b32 v32, 16, v32
    ds_write_b32 v50, v44 offset:4
K2_NOPEND_74:
    s_mov_b64 exec, -1
    v_cmp_gt_u32 vcc, 30, v89
    v_cmp_gt_u32 s[68:69], s70, v89
    v_lshl_add_u32 v123, v89, 6, v123
    s_mov_b64 exec, vcc
    ds_write_b128 v123, v[72:75]
    s_andn2_b64 exec, s[68:69], vcc
    s_cbranch_execz K2_NOPEND_75
    v_or_b32 v32, 32, v32
    ds_write_b32 v50, v44 offset:4
K2_NOPEND_75:
    s_mov_b64 exec, -1
    v_cmp_gt_u32 vcc, 30, v90
    v_cmp_gt_u32 s[68:69], s70, v90
    v_lshl_add_u32 v124, v90, 6, v124
    s_mov_b64 exec, vcc
    ds_write_b128 v124, v[76:79]
    s_andn2_b64 exec, s[68:69], vcc
    s_cbranch_execz K2_NOPEND_76
    v_or_b32 v32, 64, v32
    ds_write_b32 v50, v44 offset:4
K2_NOPEND_76:
    s_mov_b64 exec, -1
    v_cmp_gt_u32 vcc, 30, v91
    v_cmp_gt_u32 s[68:69], s70, v91
    v_lshl_add_u32 v125, v91, 6, v125
    s_mov_b64 exec, vcc
    ds_write_b128 v125, v[80:83]
    s_andn2_b64 exec, s[68:69], vcc
    s_cbranch_execz K2_NOPEND_77
    v_or_b32 v32, 128, v32
    ds_write_b32 v50, v44 offset:4
K2_NOPEND_77:
    s_mov_b64 exec, -1
    v_cmp_ne_u32 vcc, 0, v110
    s_and_b64 exec, exec, vcc
    s_cbranch_execz K2_NORARE2_78
    s_waitcnt vmcnt(0) lgkmcnt(0)
    ds_write_b128 v110, v[142:145]
    ds_write_b128 v110, v[146:149] offset:16
K2_NORARE2_78:
    s_mov_b64 exec, -1
    v_cmp_ne_u32 vcc, 0, v111
    s_and_b64 exec, exec, vcc
    s_cbranch_execz K2_NORARE2_79
    s_waitcnt vmcnt(0) lgkmcnt(0)
    ds_write_b128 v111, v[150:153]
    ds_write_b128 v111, v[154:157] offset:16
K2_NORARE2_79:
    s_mov_b64 exec, -1
    v_cmp_ne_u32 vcc, 0, v112
    s_and_b64 exec, exec, vcc
    s_cbranch_execz K2_NORARE2_80
    s_waitcnt vmcnt(0) lgkmcnt(0)
    ds_write_b128 v112, v[158:161]
    ds_write_b128 v112, v[162:165] offset:16
K2_NORARE2_80:
    s_mov_b64 exec, -1
    v_cmp_ne_u32 vcc, 0, v113
    s_and_b64 exec, exec, vcc
    s_cbranch_execz K2_NORARE2_81
    s_waitcnt vmcnt(0) lgkmcnt(0)
    ds_write_b128 v113, v[166:169]
    ds_write_b128 v113, v[170:173] offset:16
K2_NORARE2_81:
    s_mov_b64 exec, -1
    v_cmp_ne_u32 vcc, 0, v114
    s_and_b64 exec, exec, vcc
    s_cbranch_execz K2_NORARE2_82
    s_waitcnt vmcnt(0) lgkmcnt(0)
    ds_write_b128 v114, v[174:177]
    ds_write_b128 v114, v[178:181] offset:16
K2_NORARE2_82:
    s_mov_b64 exec, -1
    v_cmp_ne_u32 vcc, 0, v115
    s_and_b64 exec, exec, vcc
    s_cbranch_execz K2_NORARE2_83
    s_waitcnt vmcnt(0) lgkmcnt(0)
    ds_write_b128 v115, v[182:185]
    ds_write_b128 v115, v[186:189] offset:16
K2_NORARE2_83:
    s_mov_b64 exec, -1
    v_cmp_ne_u32 vcc, 0, v116
    s_and_b64 exec, exec, vcc
    s_cbranch_execz K2_NORARE2_84
    s_waitcnt vmcnt(0) lgkmcnt(0)
    ds_write_b128 v116, v[190:193]
    ds_write_b128 v116, v[194:197] offset:16
K2_NORARE2_84:
    s_mov_b64 exec, -1
    v_cmp_ne_u32 vcc, 0, v117
    s_and_b64 exec, exec, vcc
    s_cbranch_execz K2_NORARE2_85
    s_waitcnt vmcnt(0) lgkmcnt(0)
    ds_write_b128 v117, v[198:201]
    ds_write_b128 v117, v[202:205] offset:16
K2_NORARE2_85:
    s_mov_b64 exec, -1
    s_branch K2_SCE_69
K2_SCA_68:
    s_cmp_eq_u32 s76, 0
    s_cbranch_scc1 K2_SCE_69
    s_cmp_lg_u32 s3, 3
    s_cbranch_scc1 K2_SCE_69
    s_cmp_lg_u32 s2, 45
    s_cbranch_scc1 K2_NOAGG2_86
    v_and_b32 v41, 63, v0
    v_add_u32 v100, 46, v41
    v_min_u32 v100, 255, v100
    v_mul_u32_u24 v100, 64, v100
    v_add_u32 v101, 110, v41
    v_min_u32 v101, 255, v101
    v_mul_u32_u24 v101, 64, v101
    v_add_u32 v102, 174, v41
    v_min_u32 v102, 255, v102
    v_mul_u32_u24 v102, 64, v102
    v_add_u32 v103, 238, v41
    v_min_u32 v103, 255, v103
    v_mul_u32_u24 v103, 64, v103
    s_mov_b32 s68, 108544
    s_mov_b64 s[84:85], -1
    s_mov_b64 s[86:87], -1
    s_mov_b64 s[88:89], -1
    s_mov_b64 s[90:91], -1
    s_mov_b32 s67, 131072
K2_SPIN_87:
    s_mov_b64 exec, s[84:85]
    s_cbranch_execz K2_PQ_89
    buffer_load_dword v104, v100, s[44:47], s68 offen sc1
K2_PQ_89:
    s_mov_b64 exec, s[86:87]
    s_cbranch_execz K2_PQ_90
    buffer_load_dword v105, v101, s[44:47], s68 offen sc1
K2_PQ_90:
    s_mov_b64 exec, s[88:89]
    s_cbranch_execz K2_PQ_91
    buffer_load_dword v106, v102, s[44:47], s68 offen sc1
K2_PQ_91:
    s_mov_b64 exec, s[90:91]
    s_cbranch_execz K2_PQ_92
    buffer_load_dword v107, v103, s[44:47], s68 offen sc1
K2_PQ_92:
    s_mov_b64 exec, -1
    s_waitcnt vmcnt(0)
    v_cmp_ne_u32 s[84:85], s27, v104
    v_cmp_ne_u32 s[86:87], s27, v105
    v_cmp_ne_u32 s[88:89], s27, v106
    v_cmp_ne_u32 s[90:91], s27, v107
    s_mov_b64 vcc, s[84:85]
    s_or_b64 vcc, vcc, s[86:87]
    s_or_b64 vcc, vcc, s[88:89]
    s_or_b64 vcc, vcc, s[90:91]
    s_cmp_eq_u64 vcc, 0
    s_cbranch_scc1 K2_SPINOK_88
    s_sub_u32 s67, s67, 1
    s_cbranch_scc1 K2_SPINOK_88
    s_sleep 1
    s_branch K2_SPIN_87
K2_SPINOK_88:
    s_mov_b32 s68, 141824
    v_lshlrev_b32 v41, 2, v41
    v_mov_b32 v43, s27
    s_mov_b32 exec_hi, 0
    buffer_store_dword v43, v41, s[44:47], s68 offen sc1
    s_mov_b64 exec, -1
K2_NOAGG2_86:
    s_mov_b32 s68, 141824
    v_mov_b32 v41, 0
    s_mov_b64 exec, 1
    s_mov_b32 s67, 131072
K2_SPIN_93:
    buffer_load_dword v42, v41, s[44:47], s68 offen sc1
    s_waitcnt vmcnt(0)
    v_readfirstlane_b32 s69, v42
    s_nop 1
    s_cmp_eq_u32 s69, s27
    s_cbranch_scc1 K2_SPINOK_94
    s_sub_u32 s67, s67, 1
    s_cbranch_scc1 K2_SPINOK_94
    s_sleep 2
    s_branch K2_SPIN_93
K2_SPINOK_94:
    s_mov_b64 exec, -1
    s_waitcnt vmcnt(0)
    s_branch K2_SCF_95
K2_SCE_69:
K2_SCF_95:
    s_waitcnt vmcnt(0) lgkmcnt(0)
    s_barrier
    ds_read_b32 v128, v50 offset:4
    ds_read2_b32 v[60:61], v30 offset0:3 offset1:19
    ds_read2_b32 v[62:63], v30 offset0:35 offset1:51
    ds_read_u16 v134, v31 offset:14
    s_waitcnt lgkmcnt(0)
    v_readfirstlane_b32 s60, v128
    v_mad_u32_u16 v135, v60, s64, v26
    v_mad_u32_u16 v136, v60, s64, v27
    v_mad_u32_u16 v137, v61, s64, v26
    v_mad_u32_u16 v138, v61, s64, v27
    buffer_load_dwordx4 v[140:143], v135, s[28:31], 0 offen offset:0
    buffer_load_dwordx4 v[146:149], v135, s[28:31], 0 offen offset:256
    buffer_load_dword v145, v136, s[28:31], 0 offen offset:512
    buffer_load_dword v151, v136, s[28:31], 0 offen offset:576
    buffer_load_dwordx4 v[152:155], v137, s[28:31], 0 offen offset:0
    buffer_load_dwordx4 v[158:161], v137, s[28:31], 0 offen offset:256
    buffer_load_dword v157, v138, s[28:31], 0 offen offset:512
    buffer_load_dword v163, v138, s[28:31], 0 offen offset:576
    v_mad_u32_u16 v135, v62, s64, v26
    v_mad_u32_u16 v136, v62, s64, v27
    v_mad_u32_u16 v137, v63, s64, v26
    v_mad_u32_u16 v138, v63, s64, v27
    buffer_load_dwordx4 v[164:167], v135, s[28:31], 0 offen offset:0
    buffer_load_dwordx4 v[170:173], v135, s[28:31], 0 offen offset:256
    buffer_load_dword v169, v136, s[28:31], 0 offen offset:512
    buffer_load_dword v175, v136, s[28:31], 0 offen offset:576
    buffer_load_dwordx4 v[176:179], v137, s[28:31], 0 offen offset:0
    buffer_load_dwordx4 v[182:185], v137, s[28:31], 0 offen offset:256
    buffer_load_dword v181, v138, s[28:31], 0 offen offset:512
    buffer_load_dword v187, v138, s[28:31], 0 offen offset:576
    s_add_u32 s68, s54, 2048
    s_cmp_lt_u32 s68, s26
    s_cselect_b32 s68, 2, 0
    s_or_b32 s60, s60, s68
    s_mov_b32 s63, 10
    s_mov_b64 vcc, 0
    v_mad_u32_u16 v135, v134, v28, v29
    ds_read_b128 v[92:95], v135
    ds_read2_b32 v[132:133], v30 offset0:67 offset1:83
    ds_read_u16 v134, v31 offset:142
    ds_read_b128 v[84:87], v30
    ds_read_b128 v[88:91], v30 offset:64
    s_cmp_eq_u32 s60, 0
    s_cselect_b32 s78, 0x3e, 0
    s_lshr_b32 s79, s3, 2
    s_cmp_eq_u32 s76, 0
    s_cselect_b32 s84, 1, 0
    s_or_b32 s85, s84, s60
    s_mul_i32 s68, s2, 81920
    s_add_u32 s68, s68, 191627264
    s_add_u32 s48, s24, s68
    s_addc_u32 s49, s25, 0
    s_mov_b32 s50, 81920
    s_mov_b32 s51, 0x20000
    v_and_b32 v35, 0xff, v35
    s_add_u32 s58, s58, 128
    s_lshr_b32 s59, s59, 1
    v_lshl_add_u32 v38, v35, 9, v27
    s_bitcmp1_b32 s59, 0
    s_cselect_b32 s68, 112, 0
    s_xor_b32 s68, s68, s58
    v_add_u32 v35, s68, v33
    ds_read2_b32 v[120:121], v38 offset0:0 offset1:16
    ds_read2_b32 v[122:123], v38 offset0:32 offset1:48
    ds_read2_b32 v[124:125], v38 offset0:64 offset1:80
    ds_read2_b32 v[126:127], v38 offset0:96 offset1:112
    ds_read_b32 v35, v35
    s_waitcnt lgkmcnt(0)
    v_and_b32 v40, s65, v122
    v_and_b32 v41, s65, v124
    v_and_b32 v42, s65, v126
    v_and_b32 v43, s65, v120
    v_lshlrev_b32 v44, 16, v122
    v_lshlrev_b32 v45, 16, v124
    v_lshlrev_b32 v46, 16, v126
    v_lshlrev_b32 v47, 16, v120
    v_mov_b64 v[48:49], 0
    v_and_b32 v50, s65, v123
    v_and_b32 v51, s65, v125
    v_and_b32 v52, s65, v127
    v_and_b32 v53, s65, v121
    v_lshlrev_b32 v54, 16, v123
    v_lshlrev_b32 v55, 16, v125
    v_lshlrev_b32 v56, 16, v127
    v_lshlrev_b32 v57, 16, v121
    v_mov_b64 v[58:59], 0
    v_mov_b32 v36, v38
    s_cmp_eq_u32 s84, 0
    s_cbranch_scc1 K2_LQ_126
    s_call_b64 s[6:7], K2_LOREAD_124
K2_LQ_126:
    v_and_b32 v35, 0xff, v35
    s_add_u32 s58, s58, 128
    s_lshr_b32 s59, s59, 1
    v_lshl_add_u32 v38, v35, 9, v27
    s_bitcmp1_b32 s59, 0
    s_cselect_b32 s68, 112, 0
    s_xor_b32 s68, s68, s58
    v_add_u32 v35, s68, v33
    ds_read2_b32 v[120:121], v38 offset0:0 offset1:16
    ds_read2_b32 v[122:123], v38 offset0:32 offset1:48
    ds_read2_b32 v[124:125], v38 offset0:64 offset1:80
    ds_read2_b32 v[126:127], v38 offset0:96 offset1:112
    ds_read_b32 v35, v35
    s_and_b32 s62, s56, 31
    s_cbranch_scc0 K2_EZ21_116
    s_sub_u32 s62, s62, 1
K2_PH0_96:
    s_waitcnt vmcnt(8) lgkmcnt(2)
K2_PH0_96_W:
    v_mfma_f32_16x16x32_bf16 v[60:63], v[92:95], v[2:5], 0
    v_lshlrev_b64 v[104:105], 16, v[140:141]
    v_lshlrev_b64 v[106:107], 16, v[142:143]
    v_mfma_f32_16x16x32_bf16 v[64:67], v[92:95], v[6:9], 0
    v_lshlrev_b32 v144, 16, v145
    v_lshlrev_b64 v[108:109], 16, v[146:147]
    v_mfma_f32_16x16x32_bf16 v[68:71], v[92:95], v[10:13], 0
    v_lshlrev_b64 v[110:111], 16, v[148:149]
    v_lshlrev_b32 v150, 16, v151
    v_mfma_f32_16x16x32_bf16 v[72:75], v[92:95], v[14:17], 0
    v_lshlrev_b64 v[112:113], 16, v[152:153]
    v_lshlrev_b64 v[114:115], 16, v[154:155]
    v_mfma_f32_16x16x32_bf16 v[76:79], v[92:95], v[18:21], 0
    v_lshlrev_b32 v156, 16, v157
    v_lshlrev_b64 v[116:117], 16, v[158:159]
    v_mfma_f32_16x16x32_bf16 v[80:83], v[92:95], v[22:25], 0
    v_lshlrev_b64 v[118:119], 16, v[160:161]
    v_lshlrev_b32 v162, 16, v163
    s_sub_u32 s55, s55, 1
    s_cmp_lt_u32 s55, 2
    s_cbranch_scc1 K2_SK0_99
    v_mad_u32_u16 v135, v132, s64, v26
    v_mad_u32_u16 v136, v132, s64, v27
    v_mad_u32_u16 v137, v133, s64, v26
    v_mad_u32_u16 v138, v133, s64, v27
    buffer_load_dwordx4 v[188:191], v135, s[28:31], 0 offen offset:0
    buffer_load_dwordx4 v[194:197], v135, s[28:31], 0 offen offset:256
    buffer_load_dword v193, v136, s[28:31], 0 offen offset:512
    buffer_load_dword v199, v136, s[28:31], 0 offen offset:576
    buffer_load_dwordx4 v[200:203], v137, s[28:31], 0 offen offset:0
    buffer_load_dwordx4 v[206:209], v137, s[28:31], 0 offen offset:256
    buffer_load_dword v205, v138, s[28:31], 0 offen offset:512
    buffer_load_dword v211, v138, s[28:31], 0 offen offset:576
K2_BK0_102:
    v_mad_u32_u16 v128, v134, v28, v29
    ds_read_b128 v[92:95], v128
    ds_read2_b32 v[132:133], v30 offset0:99 offset1:115
    ds_read_u16 v134, v31 offset:270
    s_waitcnt lgkmcnt(3)
    v_pk_fma_f32 v[40:41], v[60:61], v[140:141], v[40:41] op_sel_hi:[0,1,1]
    v_pk_fma_f32 v[50:51], v[72:73], v[146:147], v[50:51] op_sel_hi:[0,1,1]
    v_pk_mul_f32 v[128:129], v[68:69], v[144:145]
    v_pk_mul_f32 v[130:131], v[80:81], v[150:151]
    v_pk_fma_f32 v[42:43], v[60:61], v[142:143], v[42:43]
    v_pk_fma_f32 v[52:53], v[72:73], v[148:149], v[52:53]
    v_pk_fma_f32 v[44:45], v[64:65], v[104:105], v[44:45] op_sel_hi:[0,1,1]
    v_pk_fma_f32 v[54:55], v[76:77], v[108:109], v[54:55] op_sel_hi:[0,1,1]
    v_pk_fma_f32 v[46:47], v[64:65], v[106:107], v[46:47]
    v_pk_fma_f32 v[56:57], v[76:77], v[110:111], v[56:57]
    v_pk_fma_f32 v[48:49], v[128:129], v[86:87], v[48:49] op_sel_hi:[1,0,1]
    v_pk_fma_f32 v[58:59], v[130:131], v[86:87], v[58:59] op_sel_hi:[1,0,1]
    v_pk_fma_f32 v[40:41], v[128:129], v[84:85], v[40:41] op_sel:[1,0,0]
    v_pk_fma_f32 v[50:51], v[130:131], v[84:85], v[50:51] op_sel:[1,0,0]
    v_pk_fma_f32 v[44:45], v[128:129], v[84:85], v[44:45] op_sel_hi:[0,1,1]
    v_pk_fma_f32 v[54:55], v[130:131], v[84:85], v[54:55] op_sel_hi:[0,1,1]
    ds_read_b128 v[84:87], v30 offset:128
    s_sub_u32 s62, s62, 1
    s_cbranch_scc1 K2_EP00_105
K2_RT00_117:
    v_pk_fma_f32 v[40:41], v[62:63], v[152:153], v[40:41] op_sel_hi:[0,1,1]
    v_pk_fma_f32 v[50:51], v[74:75], v[158:159], v[50:51] op_sel_hi:[0,1,1]
    v_pk_mul_f32 v[128:129], v[70:71], v[156:157]
    v_pk_mul_f32 v[130:131], v[82:83], v[162:163]
    v_pk_fma_f32 v[42:43], v[62:63], v[154:155], v[42:43]
    v_pk_fma_f32 v[52:53], v[74:75], v[160:161], v[52:53]
    v_pk_fma_f32 v[44:45], v[66:67], v[112:113], v[44:45] op_sel_hi:[0,1,1]
    v_pk_fma_f32 v[54:55], v[78:79], v[116:117], v[54:55] op_sel_hi:[0,1,1]
    v_pk_fma_f32 v[46:47], v[66:67], v[114:115], v[46:47]
    v_pk_fma_f32 v[56:57], v[78:79], v[118:119], v[56:57]
    v_pk_fma_f32 v[48:49], v[128:129], v[90:91], v[48:49] op_sel_hi:[1,0,1]
    v_pk_fma_f32 v[58:59], v[130:131], v[90:91], v[58:59] op_sel_hi:[1,0,1]
    v_pk_fma_f32 v[40:41], v[128:129], v[88:89], v[40:41] op_sel:[1,0,0]
    v_pk_fma_f32 v[50:51], v[130:131], v[88:89], v[50:51] op_sel:[1,0,0]
    v_pk_fma_f32 v[44:45], v[128:129], v[88:89], v[44:45] op_sel_hi:[0,1,1]
    v_pk_fma_f32 v[54:55], v[130:131], v[88:89], v[54:55] op_sel_hi:[0,1,1]
    ds_read_b128 v[88:91], v30 offset:192
    s_sub_u32 s62, s62, 1
    s_cbranch_scc1 K2_EP01_106
K2_RT01_118:
K2_PH1_97:
    s_waitcnt vmcnt(8) lgkmcnt(2)
K2_PH1_97_W:
    v_mfma_f32_16x16x32_bf16 v[60:63], v[92:95], v[2:5], 0
    v_lshlrev_b64 v[104:105], 16, v[164:165]
    v_lshlrev_b64 v[106:107], 16, v[166:167]
    v_mfma_f32_16x16x32_bf16 v[64:67], v[92:95], v[6:9], 0
    v_lshlrev_b32 v168, 16, v169
    v_lshlrev_b64 v[108:109], 16, v[170:171]
    v_mfma_f32_16x16x32_bf16 v[68:71], v[92:95], v[10:13], 0
    v_lshlrev_b64 v[110:111], 16, v[172:173]
    v_lshlrev_b32 v174, 16, v175
    v_mfma_f32_16x16x32_bf16 v[72:75], v[92:95], v[14:17], 0
    v_lshlrev_b64 v[112:113], 16, v[176:177]
    v_lshlrev_b64 v[114:115], 16, v[178:179]
    v_mfma_f32_16x16x32_bf16 v[76:79], v[92:95], v[18:21], 0
    v_lshlrev_b32 v180, 16, v181
    v_lshlrev_b64 v[116:117], 16, v[182:183]
    v_mfma_f32_16x16x32_bf16 v[80:83], v[92:95], v[22:25], 0
    v_lshlrev_b64 v[118:119], 16, v[184:185]
    v_lshlrev_b32 v186, 16, v187
    s_sub_u32 s55, s55, 1
    s_cmp_lt_u32 s55, 2
    s_cbranch_scc1 K2_SK1_100
    v_mad_u32_u16 v135, v132, s64, v26
    v_mad_u32_u16 v136, v132, s64, v27
    v_mad_u32_u16 v137, v133, s64, v26
    v_mad_u32_u16 v138, v133, s64, v27
    buffer_load_dwordx4 v[140:143], v135, s[28:31], 0 offen offset:0
    buffer_load_dwordx4 v[146:149], v135, s[28:31], 0 offen offset:256
    buffer_load_dword v145, v136, s[28:31], 0 offen offset:512
    buffer_load_dword v151, v136, s[28:31], 0 offen offset:576
    buffer_load_dwordx4 v[152:155], v137, s[28:31], 0 offen offset:0
    buffer_load_dwordx4 v[158:161], v137, s[28:31], 0 offen offset:256
    buffer_load_dword v157, v138, s[28:31], 0 offen offset:512
    buffer_load_dword v163, v138, s[28:31], 0 offen offset:576
K2_BK1_103:
    v_mad_u32_u16 v128, v134, v28, v29
    ds_read_b128 v[92:95], v128
    ds_read2_b32 v[132:133], v30 offset0:131 offset1:147
    ds_read_u16 v134, v31 offset:398
    s_waitcnt lgkmcnt(3)
    v_pk_fma_f32 v[40:41], v[60:61], v[164:165], v[40:41] op_sel_hi:[0,1,1]
    v_pk_fma_f32 v[50:51], v[72:73], v[170:171], v[50:51] op_sel_hi:[0,1,1]
    v_pk_mul_f32 v[128:129], v[68:69], v[168:169]
    v_pk_mul_f32 v[130:131], v[80:81], v[174:175]
    v_pk_fma_f32 v[42:43], v[60:61], v[166:167], v[42:43]
    v_pk_fma_f32 v[52:53], v[72:73], v[172:173], v[52:53]
    v_pk_fma_f32 v[44:45], v[64:65], v[104:105], v[44:45] op_sel_hi:[0,1,1]
    v_pk_fma_f32 v[54:55], v[76:77], v[108:109], v[54:55] op_sel_hi:[0,1,1]
    v_pk_fma_f32 v[46:47], v[64:65], v[106:107], v[46:47]
    v_pk_fma_f32 v[56:57], v[76:77], v[110:111], v[56:57]
    v_pk_fma_f32 v[48:49], v[128:129], v[86:87], v[48:49] op_sel_hi:[1,0,1]
    v_pk_fma_f32 v[58:59], v[130:131], v[86:87], v[58:59] op_sel_hi:[1,0,1]
    v_pk_fma_f32 v[40:41], v[128:129], v[84:85], v[40:41] op_sel:[1,0,0]
    v_pk_fma_f32 v[50:51], v[130:131], v[84:85], v[50:51] op_sel:[1,0,0]
    v_pk_fma_f32 v[44:45], v[128:129], v[84:85], v[44:45] op_sel_hi:[0,1,1]
    v_pk_fma_f32 v[54:55], v[130:131], v[84:85], v[54:55] op_sel_hi:[0,1,1]
    ds_read_b128 v[84:87], v30 offset:256
    s_sub_u32 s62, s62, 1
    s_cbranch_scc1 K2_EP10_107
K2_RT10_119:
    v_pk_fma_f32 v[40:41], v[62:63], v[176:177], v[40:41] op_sel_hi:[0,1,1]
    v_pk_fma_f32 v[50:51], v[74:75], v[182:183], v[50:51] op_sel_hi:[0,1,1]
    v_pk_mul_f32 v[128:129], v[70:71], v[180:181]
    v_pk_mul_f32 v[130:131], v[82:83], v[186:187]
    v_pk_fma_f32 v[42:43], v[62:63], v[178:179], v[42:43]
    v_pk_fma_f32 v[52:53], v[74:75], v[184:185], v[52:53]
    v_pk_fma_f32 v[44:45], v[66:67], v[112:113], v[44:45] op_sel_hi:[0,1,1]
    v_pk_fma_f32 v[54:55], v[78:79], v[116:117], v[54:55] op_sel_hi:[0,1,1]
    v_pk_fma_f32 v[46:47], v[66:67], v[114:115], v[46:47]
    v_pk_fma_f32 v[56:57], v[78:79], v[118:119], v[56:57]
    v_pk_fma_f32 v[48:49], v[128:129], v[90:91], v[48:49] op_sel_hi:[1,0,1]
    v_pk_fma_f32 v[58:59], v[130:131], v[90:91], v[58:59] op_sel_hi:[1,0,1]
    v_pk_fma_f32 v[40:41], v[128:129], v[88:89], v[40:41] op_sel:[1,0,0]
    v_pk_fma_f32 v[50:51], v[130:131], v[88:89], v[50:51] op_sel:[1,0,0]
    v_pk_fma_f32 v[44:45], v[128:129], v[88:89], v[44:45] op_sel_hi:[0,1,1]
    v_pk_fma_f32 v[54:55], v[130:131], v[88:89], v[54:55] op_sel_hi:[0,1,1]
    ds_read_b128 v[88:91], v30 offset:320
    s_sub_u32 s62, s62, 1
    s_cbranch_scc1 K2_EP11_108
K2_RT11_120:
K2_PH2_98:
    s_waitcnt vmcnt(8) lgkmcnt(2)
K2_PH2_98_W:
    v_mfma_f32_16x16x32_bf16 v[60:63], v[92:95], v[2:5], 0
    v_lshlrev_b64 v[104:105], 16, v[188:189]
    v_lshlrev_b64 v[106:107], 16, v[190:191]
    v_mfma_f32_16x16x32_bf16 v[64:67], v[92:95], v[6:9], 0
    v_lshlrev_b32 v192, 16, v193
    v_lshlrev_b64 v[108:109], 16, v[194:195]
    v_mfma_f32_16x16x32_bf16 v[68:71], v[92:95], v[10:13], 0
    v_lshlrev_b64 v[110:111], 16, v[196:197]
    v_lshlrev_b32 v198, 16, v199
    v_mfma_f32_16x16x32_bf16 v[72:75], v[92:95], v[14:17], 0
    v_lshlrev_b64 v[112:113], 16, v[200:201]
    v_lshlrev_b64 v[114:115], 16, v[202:203]
    v_mfma_f32_16x16x32_bf16 v[76:79], v[92:95], v[18:21], 0
    v_lshlrev_b32 v204, 16, v205
    v_lshlrev_b64 v[116:117], 16, v[206:207]
    v_mfma_f32_16x16x32_bf16 v[80:83], v[92:95], v[22:25], 0
    v_lshlrev_b64 v[118:119], 16, v[208:209]
    v_lshlrev_b32 v210, 16, v211
    s_sub_u32 s55, s55, 1
    s_cmp_lt_u32 s55, 2
    s_cbranch_scc1 K2_SK2_101
    v_mad_u32_u16 v135, v132, s64, v26
    v_mad_u32_u16 v136, v132, s64, v27
    v_mad_u32_u16 v137, v133, s64, v26
    v_mad_u32_u16 v138, v133, s64, v27
    buffer_load_dwordx4 v[164:167], v135, s[28:31], 0 offen offset:0
    buffer_load_dwordx4 v[170:173], v135, s[28:31], 0 offen offset:256
    buffer_load_dword v169, v136, s[28:31], 0 offen offset:512
    buffer_load_dword v175, v136, s[28:31], 0 offen offset:576
    buffer_load_dwordx4 v[176:179], v137, s[28:31], 0 offen offset:0
    buffer_load_dwordx4 v[182:185], v137, s[28:31], 0 offen offset:256
    buffer_load_dword v181, v138, s[28:31], 0 offen offset:512
    buffer_load_dword v187, v138, s[28:31], 0 offen offset:576
K2_BK2_104:
    v_mad_u32_u16 v128, v134, v28, v29
    ds_read_b128 v[92:95], v128
    ds_read2_b32 v[132:133], v30 offset0:163 offset1:179
    ds_read_u16 v134, v31 offset:526
    s_waitcnt lgkmcnt(3)
    v_pk_fma_f32 v[40:41], v[60:61], v[188:189], v[40:41] op_sel_hi:[0,1,1]
    v_pk_fma_f32 v[50:51], v[72:73], v[194:195], v[50:51] op_sel_hi:[0,1,1]
    v_pk_mul_f32 v[128:129], v[68:69], v[192:193]
    v_pk_mul_f32 v[130:131], v[80:81], v[198:199]
    v_pk_fma_f32 v[42:43], v[60:61], v[190:191], v[42:43]
    v_pk_fma_f32 v[52:53], v[72:73], v[196:197], v[52:53]
    v_pk_fma_f32 v[44:45], v[64:65], v[104:105], v[44:45] op_sel_hi:[0,1,1]
    v_pk_fma_f32 v[54:55], v[76:77], v[108:109], v[54:55] op_sel_hi:[0,1,1]
    v_pk_fma_f32 v[46:47], v[64:65], v[106:107], v[46:47]
    v_pk_fma_f32 v[56:57], v[76:77], v[110:111], v[56:57]
    v_pk_fma_f32 v[48:49], v[128:129], v[86:87], v[48:49] op_sel_hi:[1,0,1]
    v_pk_fma_f32 v[58:59], v[130:131], v[86:87], v[58:59] op_sel_hi:[1,0,1]
    v_pk_fma_f32 v[40:41], v[128:129], v[84:85], v[40:41] op_sel:[1,0,0]
    v_pk_fma_f32 v[50:51], v[130:131], v[84:85], v[50:51] op_sel:[1,0,0]
    v_pk_fma_f32 v[44:45], v[128:129], v[84:85], v[44:45] op_sel_hi:[0,1,1]
    v_pk_fma_f32 v[54:55], v[130:131], v[84:85], v[54:55] op_sel_hi:[0,1,1]
    ds_read_b128 v[84:87], v30 offset:384
    s_sub_u32 s62, s62, 1
    s_cbranch_scc1 K2_EP20_109
K2_RT20_121:
    v_pk_fma_f32 v[40:41], v[62:63], v[200:201], v[40:41] op_sel_hi:[0,1,1]
    v_pk_fma_f32 v[50:51], v[74:75], v[206:207], v[50:51] op_sel_hi:[0,1,1]
    v_pk_mul_f32 v[128:129], v[70:71], v[204:205]
    v_pk_mul_f32 v[130:131], v[82:83], v[210:211]
    v_pk_fma_f32 v[42:43], v[62:63], v[202:203], v[42:43]
    v_pk_fma_f32 v[52:53], v[74:75], v[208:209], v[52:53]
    v_pk_fma_f32 v[44:45], v[66:67], v[112:113], v[44:45] op_sel_hi:[0,1,1]
    v_pk_fma_f32 v[54:55], v[78:79], v[116:117], v[54:55] op_sel_hi:[0,1,1]
    v_pk_fma_f32 v[46:47], v[66:67], v[114:115], v[46:47]
    v_pk_fma_f32 v[56:57], v[78:79], v[118:119], v[56:57]
    v_pk_fma_f32 v[48:49], v[128:129], v[90:91], v[48:49] op_sel_hi:[1,0,1]
    v_pk_fma_f32 v[58:59], v[130:131], v[90:91], v[58:59] op_sel_hi:[1,0,1]
    v_pk_fma_f32 v[40:41], v[128:129], v[88:89], v[40:41] op_sel:[1,0,0]
    v_pk_fma_f32 v[50:51], v[130:131], v[88:89], v[50:51] op_sel:[1,0,0]
    v_pk_fma_f32 v[44:45], v[128:129], v[88:89], v[44:45] op_sel_hi:[0,1,1]
    v_pk_fma_f32 v[54:55], v[130:131], v[88:89], v[54:55] op_sel_hi:[0,1,1]
    ds_read_b128 v[88:91], v30 offset:448
    v_add_u32 v30, 384, v30
    v_add_u32 v31, 384, v31
    s_sub_u32 s62, s62, 1
    s_cbranch_scc0 K2_PH0_96
K2_EP21_110:
    v_add_f32 v46, v46, v48
    v_add_f32 v42, v42, v49
    v_cvt_pk_bf16_f32 v96, v47, v43
    v_cvt_pk_bf16_f32 v98, v44, v40
    v_cvt_pk_bf16_f32 v100, v45, v41
    v_cvt_pk_bf16_f32 v102, v46, v42
    v_add_f32 v56, v56, v58
    v_add_f32 v52, v52, v59
    v_cvt_pk_bf16_f32 v97, v57, v53
    v_cvt_pk_bf16_f32 v99, v54, v50
    v_cvt_pk_bf16_f32 v101, v55, v51
    v_cvt_pk_bf16_f32 v103, v56, v52
    s_waitcnt lgkmcnt(1)
    s_bitcmp1_b32 s78, s63
    s_cbranch_scc0 K2_PW_127
    v_lshl_add_u32 v37, v36, 8, v34
    buffer_store_dword v96, v37, s[36:39], 0 offen offset:0 nt
    buffer_store_dword v97, v37, s[36:39], 0 offen offset:64 nt
    buffer_store_dword v98, v37, s[36:39], 0 offen offset:512 nt
    buffer_store_dword v99, v37, s[36:39], 0 offen offset:576 nt
    buffer_store_dword v100, v37, s[36:39], 0 offen offset:1024 nt
    buffer_store_dword v101, v37, s[36:39], 0 offen offset:1088 nt
    buffer_store_dword v102, v37, s[36:39], 0 offen offset:1536 nt
    buffer_store_dword v103, v37, s[36:39], 0 offen offset:1600 nt
K2_NX_128:
    s_lshr_b32 s56, s56, 5
    s_sub_u32 s63, s63, 1
    s_cmp_eq_u32 s63, 0
    s_cbranch_scc1 K2_DONE_123
K2_IN_130:
    s_xor_b32 s79, s79, 1
    s_setprio 0
    s_cbranch_scc0 K2_P0_131
    s_setprio 1
K2_P0_131:
    v_and_b32 v40, s65, v122
    v_and_b32 v41, s65, v124
    v_and_b32 v42, s65, v126
    v_and_b32 v43, s65, v120
    v_lshlrev_b32 v44, 16, v122
    v_lshlrev_b32 v45, 16, v124
    v_lshlrev_b32 v46, 16, v126
    v_lshlrev_b32 v47, 16, v120
    v_mov_b64 v[48:49], 0
    v_and_b32 v50, s65, v123
    v_and_b32 v51, s65, v125
    v_and_b32 v52, s65, v127
    v_and_b32 v53, s65, v121
    v_lshlrev_b32 v54, 16, v123
    v_lshlrev_b32 v55, 16, v125
    v_lshlrev_b32 v56, 16, v127
    v_lshlrev_b32 v57, 16, v121
    v_mov_b64 v[58:59], 0
    v_mov_b32 v36, v38
    s_cmp_lg_u32 s84, 0
    s_cbranch_scc1 K2_RC_134
K2_RB_135:
    v_and_b32 v35, 0xff, v35
    s_add_u32 s58, s58, 128
    s_lshr_b32 s59, s59, 1
    v_lshl_add_u32 v38, v35, 9, v27
    s_bitcmp1_b32 s59, 0
    s_cselect_b32 s68, 112, 0
    s_xor_b32 s68, s68, s58
    v_add_u32 v35, s68, v33
    ds_read2_b32 v[120:121], v38 offset0:0 offset1:16
    ds_read2_b32 v[122:123], v38 offset0:32 offset1:48
    ds_read2_b32 v[124:125], v38 offset0:64 offset1:80
    ds_read2_b32 v[126:127], v38 offset0:96 offset1:112
    ds_read_b32 v35, v35
    s_and_b32 s62, s56, 31
    s_cbranch_scc0 K2_EZ21_116
    s_sub_u32 s62, s62, 1
    s_waitcnt vmcnt(8)
    s_branch K2_PH0_96_W
K2_EZ21_116:
    s_waitcnt lgkmcnt(0)
    s_branch K2_EP21_110
K2_RC_134:
    s_call_b64 s[6:7], K2_LOREAD_124
    s_branch K2_RB_135
K2_WC_132:
    s_call_b64 s[6:7], K2_LOWRITE_125
    s_branch K2_WB_133
K2_PW_127:
    ds_write2_b32 v36, v96, v97 offset0:0 offset1:16
    ds_write2_b32 v36, v98, v99 offset0:32 offset1:48
    ds_write2_b32 v36, v100, v101 offset0:64 offset1:80
    ds_write2_b32 v36, v102, v103 offset0:96 offset1:112
    s_cmp_lg_u32 s85, 0
    s_cbranch_scc1 K2_WC_132
K2_WB_133:
    s_cmp_lg_u32 s63, 6
    s_cbranch_scc1 K2_NX_128
    s_mov_b32 s84, s85
    s_mov_b32 s63, 5
    s_mov_b32 s56, s57
    s_waitcnt lgkmcnt(0)
    s_barrier
    ds_read2_b32 v[120:121], v38 offset0:0 offset1:16
    ds_read2_b32 v[122:123], v38 offset0:32 offset1:48
    ds_read2_b32 v[124:125], v38 offset0:64 offset1:80
    ds_read2_b32 v[126:127], v38 offset0:96 offset1:112
    s_waitcnt lgkmcnt(0)
    s_branch K2_IN_130
K2_EP00_105:
    v_add_f32 v46, v46, v48
    v_add_f32 v42, v42, v49
    v_cvt_pk_bf16_f32 v96, v47, v43
    v_cvt_pk_bf16_f32 v98, v44, v40
    v_cvt_pk_bf16_f32 v100, v45, v41
    v_cvt_pk_bf16_f32 v102, v46, v42
    v_add_f32 v56, v56, v58
    v_add_f32 v52, v52, v59
    v_cvt_pk_bf16_f32 v97, v57, v53
    v_cvt_pk_bf16_f32 v99, v54, v50
    v_cvt_pk_bf16_f32 v101, v55, v51
    v_cvt_pk_bf16_f32 v103, v56, v52
    s_waitcnt lgkmcnt(1)
    s_bitcmp1_b32 s78, s63
    s_cbranch_scc0 K2_PW_136
    v_lshl_add_u32 v37, v36, 8, v34
    buffer_store_dword v96, v37, s[36:39], 0 offen offset:0 nt
    buffer_store_dword v97, v37, s[36:39], 0 offen offset:64 nt
    buffer_store_dword v98, v37, s[36:39], 0 offen offset:512 nt
    buffer_store_dword v99, v37, s[36:39], 0 offen offset:576 nt
    buffer_store_dword v100, v37, s[36:39], 0 offen offset:1024 nt
    buffer_store_dword v101, v37, s[36:39], 0 offen offset:1088 nt
    buffer_store_dword v102, v37, s[36:39], 0 offen offset:1536 nt
    buffer_store_dword v103, v37, s[36:39], 0 offen offset:1600 nt
K2_NX_137:
    s_lshr_b32 s56, s56, 5
    s_sub_u32 s63, s63, 1
    s_cmp_eq_u32 s63, 0
    s_cbranch_scc1 K2_DONE_123
K2_IN_139:
    s_xor_b32 s79, s79, 1
    s_setprio 0
    s_cbranch_scc0 K2_P0_140
    s_setprio 1
K2_P0_140:
    v_and_b32 v40, s65, v122
    v_and_b32 v41, s65, v124
    v_and_b32 v42, s65, v126
    v_and_b32 v43, s65, v120
    v_lshlrev_b32 v44, 16, v122
    v_lshlrev_b32 v45, 16, v124
    v_lshlrev_b32 v46, 16, v126
    v_lshlrev_b32 v47, 16, v120
    v_mov_b64 v[48:49], 0
    v_and_b32 v50, s65, v123
    v_and_b32 v51, s65, v125
    v_and_b32 v52, s65, v127
    v_and_b32 v53, s65, v121
    v_lshlrev_b32 v54, 16, v123
    v_lshlrev_b32 v55, 16, v125
    v_lshlrev_b32 v56, 16, v127
    v_lshlrev_b32 v57, 16, v121
    v_mov_b64 v[58:59], 0
    v_mov_b32 v36, v38
    s_cmp_lg_u32 s84, 0
    s_cbranch_scc1 K2_RC_143
K2_RB_144:
    v_and_b32 v35, 0xff, v35
    s_add_u32 s58, s58, 128
    s_lshr_b32 s59, s59, 1
    v_lshl_add_u32 v38, v35, 9, v27
    s_bitcmp1_b32 s59, 0
    s_cselect_b32 s68, 112, 0
    s_xor_b32 s68, s68, s58
    v_add_u32 v35, s68, v33
    ds_read2_b32 v[120:121], v38 offset0:0 offset1:16
    ds_read2_b32 v[122:123], v38 offset0:32 offset1:48
    ds_read2_b32 v[124:125], v38 offset0:64 offset1:80
    ds_read2_b32 v[126:127], v38 offset0:96 offset1:112
    ds_read_b32 v35, v35
    s_and_b32 s62, s56, 31
    s_cbranch_scc0 K2_EZ00_111
    s_sub_u32 s62, s62, 1
    s_branch K2_RT00_117
K2_EZ00_111:
    s_waitcnt lgkmcnt(0)
    s_branch K2_EP00_105
K2_RC_143:
    s_call_b64 s[6:7], K2_LOREAD_124
    s_branch K2_RB_144
K2_WC_141:
    s_call_b64 s[6:7], K2_LOWRITE_125
    s_branch K2_WB_142
K2_PW_136:
    ds_write2_b32 v36, v96, v97 offset0:0 offset1:16
    ds_write2_b32 v36, v98, v99 offset0:32 offset1:48
    ds_write2_b32 v36, v100, v101 offset0:64 offset1:80
    ds_write2_b32 v36, v102, v103 offset0:96 offset1:112
    s_cmp_lg_u32 s85, 0
    s_cbranch_scc1 K2_WC_141
K2_WB_142:
    s_cmp_lg_u32 s63, 6
    s_cbranch_scc1 K2_NX_137
    s_mov_b32 s84, s85
    s_mov_b32 s63, 5
    s_mov_b32 s56, s57
    s_waitcnt lgkmcnt(0)
    s_barrier
    ds_read2_b32 v[120:121], v38 offset0:0 offset1:16
    ds_read2_b32 v[122:123], v38 offset0:32 offset1:48
    ds_read2_b32 v[124:125], v38 offset0:64 offset1:80
    ds_read2_b32 v[126:127], v38 offset0:96 offset1:112
    s_waitcnt lgkmcnt(0)
    s_branch K2_IN_139
K2_EP01_106:
    v_add_f32 v46, v46, v48
    v_add_f32 v42, v42, v49
    v_cvt_pk_bf16_f32 v96, v47, v43
    v_cvt_pk_bf16_f32 v98, v44, v40
    v_cvt_pk_bf16_f32 v100, v45, v41
    v_cvt_pk_bf16_f32 v102, v46, v42
    v_add_f32 v56, v56, v58
    v_add_f32 v52, v52, v59
    v_cvt_pk_bf16_f32 v97, v57, v53
    v_cvt_pk_bf16_f32 v99, v54, v50
    v_cvt_pk_bf16_f32 v101, v55, v51
    v_cvt_pk_bf16_f32 v103, v56, v52
    s_waitcnt lgkmcnt(1)
    s_bitcmp1_b32 s78, s63
    s_cbranch_scc0 K2_PW_145
    v_lshl_add_u32 v37, v36, 8, v34
    buffer_store_dword v96, v37, s[36:39], 0 offen offset:0 nt
    buffer_store_dword v97, v37, s[36:39], 0 offen offset:64 nt
    buffer_store_dword v98, v37, s[36:39], 0 offen offset:512 nt
    buffer_store_dword v99, v37, s[36:39], 0 offen offset:576 nt
    buffer_store_dword v100, v37, s[36:39], 0 offen offset:1024 nt
    buffer_store_dword v101, v37, s[36:39], 0 offen offset:1088 nt
    buffer_store_dword v102, v37, s[36:39], 0 offen offset:1536 nt
    buffer_store_dword v103, v37, s[36:39], 0 offen offset:1600 nt
K2_NX_146:
    s_lshr_b32 s56, s56, 5
    s_sub_u32 s63, s63, 1
    s_cmp_eq_u32 s63, 0
    s_cbranch_scc1 K2_DONE_123
K2_IN_148:
    s_xor_b32 s79, s79, 1
    s_setprio 0
    s_cbranch_scc0 K2_P0_149
    s_setprio 1
K2_P0_149:
    v_and_b32 v40, s65, v122
    v_and_b32 v41, s65, v124
    v_and_b32 v42, s65, v126
    v_and_b32 v43, s65, v120
    v_lshlrev_b32 v44, 16, v122
    v_lshlrev_b32 v45, 16, v124
    v_lshlrev_b32 v46, 16, v126
    v_lshlrev_b32 v47, 16, v120
    v_mov_b64 v[48:49], 0
    v_and_b32 v50, s65, v123
    v_and_b32 v51, s65, v125
    v_and_b32 v52, s65, v127
    v_and_b32 v53, s65, v121
    v_lshlrev_b32 v54, 16, v123
    v_lshlrev_b32 v55, 16, v125
    v_lshlrev_b32 v56, 16, v127
    v_lshlrev_b32 v57, 16, v121
    v_mov_b64 v[58:59], 0
    v_mov_b32 v36, v38
    s_cmp_lg_u32 s84, 0
    s_cbranch_scc1 K2_RC_152
K2_RB_153:
    v_and_b32 v35, 0xff, v35
    s_add_u32 s58, s58, 128
    s_lshr_b32 s59, s59, 1
    v_lshl_add_u32 v38, v35, 9, v27
    s_bitcmp1_b32 s59, 0
    s_cselect_b32 s68, 112, 0
    s_xor_b32 s68, s68, s58
    v_add_u32 v35, s68, v33
    ds_read2_b32 v[120:121], v38 offset0:0 offset1:16
    ds_read2_b32 v[122:123], v38 offset0:32 offset1:48
    ds_read2_b32 v[124:125], v38 offset0:64 offset1:80
    ds_read2_b32 v[126:127], v38 offset0:96 offset1:112
    ds_read_b32 v35, v35
    s_and_b32 s62, s56, 31
    s_cbranch_scc0 K2_EZ01_112
    s_sub_u32 s62, s62, 1
    s_waitcnt vmcnt(8)
    s_branch K2_PH1_97_W
K2_EZ01_112:
    s_waitcnt lgkmcnt(0)
    s_branch K2_EP01_106
K2_RC_152:
    s_call_b64 s[6:7], K2_LOREAD_124
    s_branch K2_RB_153
K2_WC_150:
    s_call_b64 s[6:7], K2_LOWRITE_125
    s_branch K2_WB_151
K2_PW_145:
    ds_write2_b32 v36, v96, v97 offset0:0 offset1:16
    ds_write2_b32 v36, v98, v99 offset0:32 offset1:48
    ds_write2_b32 v36, v100, v101 offset0:64 offset1:80
    ds_write2_b32 v36, v102, v103 offset0:96 offset1:112
    s_cmp_lg_u32 s85, 0
    s_cbranch_scc1 K2_WC_150
K2_WB_151:
    s_cmp_lg_u32 s63, 6
    s_cbranch_scc1 K2_NX_146
    s_mov_b32 s84, s85
    s_mov_b32 s63, 5
    s_mov_b32 s56, s57
    s_waitcnt lgkmcnt(0)
    s_barrier
    ds_read2_b32 v[120:121], v38 offset0:0 offset1:16
    ds_read2_b32 v[122:123], v38 offset0:32 offset1:48
    ds_read2_b32 v[124:125], v38 offset0:64 offset1:80
    ds_read2_b32 v[126:127], v38 offset0:96 offset1:112
    s_waitcnt lgkmcnt(0)
    s_branch K2_IN_148
K2_EP10_107:
    v_add_f32 v46, v46, v48
    v_add_f32 v42, v42, v49
    v_cvt_pk_bf16_f32 v96, v47, v43
    v_cvt_pk_bf16_f32 v98, v44, v40
    v_cvt_pk_bf16_f32 v100, v45, v41
    v_cvt_pk_bf16_f32 v102, v46, v42
    v_add_f32 v56, v56, v58
    v_add_f32 v52, v52, v59
    v_cvt_pk_bf16_f32 v97, v57, v53
    v_cvt_pk_bf16_f32 v99, v54, v50
    v_cvt_pk_bf16_f32 v101, v55, v51
    v_cvt_pk_bf16_f32 v103, v56, v52
    s_waitcnt lgkmcnt(1)
    s_bitcmp1_b32 s78, s63
    s_cbranch_scc0 K2_PW_154
    v_lshl_add_u32 v37, v36, 8, v34
    buffer_store_dword v96, v37, s[36:39], 0 offen offset:0 nt
    buffer_store_dword v97, v37, s[36:39], 0 offen offset:64 nt
    buffer_store_dword v98, v37, s[36:39], 0 offen offset:512 nt
    buffer_store_dword v99, v37, s[36:39], 0 offen offset:576 nt
    buffer_store_dword v100, v37, s[36:39], 0 offen offset:1024 nt
    buffer_store_dword v101, v37, s[36:39], 0 offen offset:1088 nt
    buffer_store_dword v102, v37, s[36:39], 0 offen offset:1536 nt
    buffer_store_dword v103, v37, s[36:39], 0 offen offset:1600 nt
K2_NX_155:
    s_lshr_b32 s56, s56, 5
    s_sub_u32 s63, s63, 1
    s_cmp_eq_u32 s63, 0
    s_cbranch_scc1 K2_DONE_123
K2_IN_157:
    s_xor_b32 s79, s79, 1
    s_setprio 0
    s_cbranch_scc0 K2_P0_158
    s_setprio 1
K2_P0_158:
    v_and_b32 v40, s65, v122
    v_and_b32 v41, s65, v124
    v_and_b32 v42, s65, v126
    v_and_b32 v43, s65, v120
    v_lshlrev_b32 v44, 16, v122
    v_lshlrev_b32 v45, 16, v124
    v_lshlrev_b32 v46, 16, v126
    v_lshlrev_b32 v47, 16, v120
    v_mov_b64 v[48:49], 0
    v_and_b32 v50, s65, v123
    v_and_b32 v51, s65, v125
    v_and_b32 v52, s65, v127
    v_and_b32 v53, s65, v121
    v_lshlrev_b32 v54, 16, v123
    v_lshlrev_b32 v55, 16, v125
    v_lshlrev_b32 v56, 16, v127
    v_lshlrev_b32 v57, 16, v121
    v_mov_b64 v[58:59], 0
    v_mov_b32 v36, v38
    s_cmp_lg_u32 s84, 0
    s_cbranch_scc1 K2_RC_161
K2_RB_162:
    v_and_b32 v35, 0xff, v35
    s_add_u32 s58, s58, 128
    s_lshr_b32 s59, s59, 1
    v_lshl_add_u32 v38, v35, 9, v27
    s_bitcmp1_b32 s59, 0
    s_cselect_b32 s68, 112, 0
    s_xor_b32 s68, s68, s58
    v_add_u32 v35, s68, v33
    ds_read2_b32 v[120:121], v38 offset0:0 offset1:16
    ds_read2_b32 v[122:123], v38 offset0:32 offset1:48
    ds_read2_b32 v[124:125], v38 offset0:64 offset1:80
    ds_read2_b32 v[126:127], v38 offset0:96 offset1:112
    ds_read_b32 v35, v35
    s_and_b32 s62, s56, 31
    s_cbranch_scc0 K2_EZ10_113
    s_sub_u32 s62, s62, 1
    s_branch K2_RT10_119
K2_EZ10_113:
    s_waitcnt lgkmcnt(0)
    s_branch K2_EP10_107
K2_RC_161:
    s_call_b64 s[6:7], K2_LOREAD_124
    s_branch K2_RB_162
K2_WC_159:
    s_call_b64 s[6:7], K2_LOWRITE_125
    s_branch K2_WB_160
K2_PW_154:
    ds_write2_b32 v36, v96, v97 offset0:0 offset1:16
    ds_write2_b32 v36, v98, v99 offset0:32 offset1:48
    ds_write2_b32 v36, v100, v101 offset0:64 offset1:80
    ds_write2_b32 v36, v102, v103 offset0:96 offset1:112
    s_cmp_lg_u32 s85, 0
    s_cbranch_scc1 K2_WC_159
K2_WB_160:
    s_cmp_lg_u32 s63, 6
    s_cbranch_scc1 K2_NX_155
    s_mov_b32 s84, s85
    s_mov_b32 s63, 5
    s_mov_b32 s56, s57
    s_waitcnt lgkmcnt(0)
    s_barrier
    ds_read2_b32 v[120:121], v38 offset0:0 offset1:16
    ds_read2_b32 v[122:123], v38 offset0:32 offset1:48
    ds_read2_b32 v[124:125], v38 offset0:64 offset1:80
    ds_read2_b32 v[126:127], v38 offset0:96 offset1:112
    s_waitcnt lgkmcnt(0)
    s_branch K2_IN_157
K2_EP11_108:
    v_add_f32 v46, v46, v48
    v_add_f32 v42, v42, v49
    v_cvt_pk_bf16_f32 v96, v47, v43
    v_cvt_pk_bf16_f32 v98, v44, v40
    v_cvt_pk_bf16_f32 v100, v45, v41
    v_cvt_pk_bf16_f32 v102, v46, v42
    v_add_f32 v56, v56, v58
    v_add_f32 v52, v52, v59
    v_cvt_pk_bf16_f32 v97, v57, v53
    v_cvt_pk_bf16_f32 v99, v54, v50
    v_cvt_pk_bf16_f32 v101, v55, v51
    v_cvt_pk_bf16_f32 v103, v56, v52
    s_waitcnt lgkmcnt(1)
    s_bitcmp1_b32 s78, s63
    s_cbranch_scc0 K2_PW_163
    v_lshl_add_u32 v37, v36, 8, v34
    buffer_store_dword v96, v37, s[36:39], 0 offen offset:0 nt
    buffer_store_dword v97, v37, s[36:39], 0 offen offset:64 nt
    buffer_store_dword v98, v37, s[36:39], 0 offen offset:512 nt
    buffer_store_dword v99, v37, s[36:39], 0 offen offset:576 nt
    buffer_store_dword v100, v37, s[36:39], 0 offen offset:1024 nt
    buffer_store_dword v101, v37, s[36:39], 0 offen offset:1088 nt
    buffer_store_dword v102, v37, s[36:39], 0 offen offset:1536 nt
    buffer_store_dword v103, v37, s[36:39], 0 offen offset:1600 nt
K2_NX_164:
    s_lshr_b32 s56, s56, 5
    s_sub_u32 s63, s63, 1
    s_cmp_eq_u32 s63, 0
    s_cbranch_scc1 K2_DONE_123
K2_IN_166:
    s_xor_b32 s79, s79, 1
    s_setprio 0
    s_cbranch_scc0 K2_P0_167
    s_setprio 1
K2_P0_167:
    v_and_b32 v40, s65, v122
    v_and_b32 v41, s65, v124
    v_and_b32 v42, s65, v126
    v_and_b32 v43, s65, v120
    v_lshlrev_b32 v44, 16, v122
    v_lshlrev_b32 v45, 16, v124
    v_lshlrev_b32 v46, 16, v126
    v_lshlrev_b32 v47, 16, v120
    v_mov_b64 v[48:49], 0
    v_and_b32 v50, s65, v123
    v_and_b32 v51, s65, v125
    v_and_b32 v52, s65, v127
    v_and_b32 v53, s65, v121
    v_lshlrev_b32 v54, 16, v123
    v_lshlrev_b32 v55, 16, v125
    v_lshlrev_b32 v56, 16, v127
    v_lshlrev_b32 v57, 16, v121
    v_mov_b64 v[58:59], 0
    v_mov_b32 v36, v38
    s_cmp_lg_u32 s84, 0
    s_cbranch_scc1 K2_RC_170
K2_RB_171:
    v_and_b32 v35, 0xff, v35
    s_add_u32 s58, s58, 128
    s_lshr_b32 s59, s59, 1
    v_lshl_add_u32 v38, v35, 9, v27
    s_bitcmp1_b32 s59, 0
    s_cselect_b32 s68, 112, 0
    s_xor_b32 s68, s68, s58
    v_add_u32 v35, s68, v33
    ds_read2_b32 v[120:121], v38 offset0:0 offset1:16
    ds_read2_b32 v[122:123], v38 offset0:32 offset1:48
    ds_read2_b32 v[124:125], v38 offset0:64 offset1:80
    ds_read2_b32 v[126:127], v38 offset0:96 offset1:112
    ds_read_b32 v35, v35
    s_and_b32 s62, s56, 31
    s_cbranch_scc0 K2_EZ11_114
    s_sub_u32 s62, s62, 1
    s_waitcnt vmcnt(8)
    s_branch K2_PH2_98_W
K2_EZ11_114:
    s_waitcnt lgkmcnt(0)
    s_branch K2_EP11_108
K2_RC_170:
    s_call_b64 s[6:7], K2_LOREAD_124
    s_branch K2_RB_171
K2_WC_168:
    s_call_b64 s[6:7], K2_LOWRITE_125
    s_branch K2_WB_169
K2_PW_163:
    ds_write2_b32 v36, v96, v97 offset0:0 offset1:16
    ds_write2_b32 v36, v98, v99 offset0:32 offset1:48
    ds_write2_b32 v36, v100, v101 offset0:64 offset1:80
    ds_write2_b32 v36, v102, v103 offset0:96 offset1:112
    s_cmp_lg_u32 s85, 0
    s_cbranch_scc1 K2_WC_168
K2_WB_169:
    s_cmp_lg_u32 s63, 6
    s_cbranch_scc1 K2_NX_164
    s_mov_b32 s84, s85
    s_mov_b32 s63, 5
    s_mov_b32 s56, s57
    s_waitcnt lgkmcnt(0)
    s_barrier
    ds_read2_b32 v[120:121], v38 offset0:0 offset1:16
    ds_read2_b32 v[122:123], v38 offset0:32 offset1:48
    ds_read2_b32 v[124:125], v38 offset0:64 offset1:80
    ds_read2_b32 v[126:127], v38 offset0:96 offset1:112
    s_waitcnt lgkmcnt(0)
    s_branch K2_IN_166
K2_EP20_109:
    v_add_f32 v46, v46, v48
    v_add_f32 v42, v42, v49
    v_cvt_pk_bf16_f32 v96, v47, v43
    v_cvt_pk_bf16_f32 v98, v44, v40
    v_cvt_pk_bf16_f32 v100, v45, v41
    v_cvt_pk_bf16_f32 v102, v46, v42
    v_add_f32 v56, v56, v58
    v_add_f32 v52, v52, v59
    v_cvt_pk_bf16_f32 v97, v57, v53
    v_cvt_pk_bf16_f32 v99, v54, v50
    v_cvt_pk_bf16_f32 v101, v55, v51
    v_cvt_pk_bf16_f32 v103, v56, v52
    s_waitcnt lgkmcnt(1)
    s_bitcmp1_b32 s78, s63
    s_cbranch_scc0 K2_PW_172
    v_lshl_add_u32 v37, v36, 8, v34
    buffer_store_dword v96, v37, s[36:39], 0 offen offset:0 nt
    buffer_store_dword v97, v37, s[36:39], 0 offen offset:64 nt
    buffer_store_dword v98, v37, s[36:39], 0 offen offset:512 nt
    buffer_store_dword v99, v37, s[36:39], 0 offen offset:576 nt
    buffer_store_dword v100, v37, s[36:39], 0 offen offset:1024 nt
    buffer_store_dword v101, v37, s[36:39], 0 offen offset:1088 nt
    buffer_store_dword v102, v37, s[36:39], 0 offen offset:1536 nt
    buffer_store_dword v103, v37, s[36:39], 0 offen offset:1600 nt
K2_NX_173:
    s_lshr_b32 s56, s56, 5
    s_sub_u32 s63, s63, 1
    s_cmp_eq_u32 s63, 0
    s_cbranch_scc1 K2_DONE_123
K2_IN_175:
    s_xor_b32 s79, s79, 1
    s_setprio 0
    s_cbranch_scc0 K2_P0_176
    s_setprio 1
K2_P0_176:
    v_and_b32 v40, s65, v122
    v_and_b32 v41, s65, v124
    v_and_b32 v42, s65, v126
    v_and_b32 v43, s65, v120
    v_lshlrev_b32 v44, 16, v122
    v_lshlrev_b32 v45, 16, v124
    v_lshlrev_b32 v46, 16, v126
    v_lshlrev_b32 v47, 16, v120
    v_mov_b64 v[48:49], 0
    v_and_b32 v50, s65, v123
    v_and_b32 v51, s65, v125
    v_and_b32 v52, s65, v127
    v_and_b32 v53, s65, v121
    v_lshlrev_b32 v54, 16, v123
    v_lshlrev_b32 v55, 16, v125
    v_lshlrev_b32 v56, 16, v127
    v_lshlrev_b32 v57, 16, v121
    v_mov_b64 v[58:59], 0
    v_mov_b32 v36, v38
    s_cmp_lg_u32 s84, 0
    s_cbranch_scc1 K2_RC_179
K2_RB_180:
    v_and_b32 v35, 0xff, v35
    s_add_u32 s58, s58, 128
    s_lshr_b32 s59, s59, 1
    v_lshl_add_u32 v38, v35, 9, v27
    s_bitcmp1_b32 s59, 0
    s_cselect_b32 s68, 112, 0
    s_xor_b32 s68, s68, s58
    v_add_u32 v35, s68, v33
    ds_read2_b32 v[120:121], v38 offset0:0 offset1:16
    ds_read2_b32 v[122:123], v38 offset0:32 offset1:48
    ds_read2_b32 v[124:125], v38 offset0:64 offset1:80
    ds_read2_b32 v[126:127], v38 offset0:96 offset1:112
    ds_read_b32 v35, v35
    s_and_b32 s62, s56, 31
    s_cbranch_scc0 K2_EZ20_115
    s_sub_u32 s62, s62, 1
    s_branch K2_RT20_121
K2_EZ20_115:
    s_waitcnt lgkmcnt(0)
    s_branch K2_EP20_109
K2_RC_179:
    s_call_b64 s[6:7], K2_LOREAD_124
    s_branch K2_RB_180
K2_WC_177:
    s_call_b64 s[6:7], K2_LOWRITE_125
    s_branch K2_WB_178
K2_PW_172:
    ds_write2_b32 v36, v96, v97 offset0:0 offset1:16
    ds_write2_b32 v36, v98, v99 offset0:32 offset1:48
    ds_write2_b32 v36, v100, v101 offset0:64 offset1:80
    ds_write2_b32 v36, v102, v103 offset0:96 offset1:112
    s_cmp_lg_u32 s85, 0
    s_cbranch_scc1 K2_WC_177
K2_WB_178:
    s_cmp_lg_u32 s63, 6
    s_cbranch_scc1 K2_NX_173
    s_mov_b32 s84, s85
    s_mov_b32 s63, 5
    s_mov_b32 s56, s57
    s_waitcnt lgkmcnt(0)
    s_barrier
    ds_read2_b32 v[120:121], v38 offset0:0 offset1:16
    ds_read2_b32 v[122:123], v38 offset0:32 offset1:48
    ds_read2_b32 v[124:125], v38 offset0:64 offset1:80
    ds_read2_b32 v[126:127], v38 offset0:96 offset1:112
    s_waitcnt lgkmcnt(0)
    s_branch K2_IN_175
K2_SK0_99:
    s_mov_b64 vcc, -1
    s_waitcnt vmcnt(0)
    s_branch K2_BK0_102
K2_SK1_100:
    s_mov_b64 vcc, -1
    s_waitcnt vmcnt(0)
    s_branch K2_BK1_103
K2_SK2_101:
    s_mov_b64 vcc, -1
    s_waitcnt vmcnt(0)
    s_branch K2_BK2_104
K2_LOWRITE_125:
    v_lshlrev_b32 v128, 16, v96
    v_and_b32 v129, s65, v96
    v_sub_f32 v47, v47, v128
    v_sub_f32 v43, v43, v129
    v_cvt_pk_bf16_f32 v47, v47, v43
    buffer_store_dword v47, v36, s[48:51], 0 offen offset:0
    v_lshlrev_b32 v128, 16, v97
    v_and_b32 v129, s65, v97
    v_sub_f32 v57, v57, v128
    v_sub_f32 v53, v53, v129
    v_cvt_pk_bf16_f32 v57, v57, v53
    buffer_store_dword v57, v36, s[48:51], 0 offen offset:64
    v_lshlrev_b32 v128, 16, v98
    v_and_b32 v129, s65, v98
    v_sub_f32 v44, v44, v128
    v_sub_f32 v40, v40, v129
    v_cvt_pk_bf16_f32 v44, v44, v40
    buffer_store_dword v44, v36, s[48:51], 0 offen offset:128
    v_lshlrev_b32 v128, 16, v99
    v_and_b32 v129, s65, v99
    v_sub_f32 v54, v54, v128
    v_sub_f32 v50, v50, v129
    v_cvt_pk_bf16_f32 v54, v54, v50
    buffer_store_dword v54, v36, s[48:51], 0 offen offset:192
    v_lshlrev_b32 v128, 16, v100
    v_and_b32 v129, s65, v100
    v_sub_f32 v45, v45, v128
    v_sub_f32 v41, v41, v129
    v_cvt_pk_bf16_f32 v45, v45, v41
    buffer_store_dword v45, v36, s[48:51], 0 offen offset:256
    v_lshlrev_b32 v128, 16, v101
    v_and_b32 v129, s65, v101
    v_sub_f32 v55, v55, v128
    v_sub_f32 v51, v51, v129
    v_cvt_pk_bf16_f32 v55, v55, v51
    buffer_store_dword v55, v36, s[48:51], 0 offen offset:320
    v_lshlrev_b32 v128, 16, v102
    v_and_b32 v129, s65, v102
    v_sub_f32 v46, v46, v128
    v_sub_f32 v42, v42, v129
    v_cvt_pk_bf16_f32 v46, v46, v42
    buffer_store_dword v46, v36, s[48:51], 0 offen offset:384
    v_lshlrev_b32 v128, 16, v103
    v_and_b32 v129, s65, v103
    v_sub_f32 v56, v56, v128
    v_sub_f32 v52, v52, v129
    v_cvt_pk_bf16_f32 v56, v56, v52
    buffer_store_dword v56, v36, s[48:51], 0 offen offset:448
    s_waitcnt vmcnt(0)
    s_setpc_b64 s[6:7]
K2_LOREAD_124:
    buffer_load_dword v96, v36, s[48:51], 0 offen offset:0 sc1
    buffer_load_dword v97, v36, s[48:51], 0 offen offset:64 sc1
    buffer_load_dword v98, v36, s[48:51], 0 offen offset:128 sc1
    buffer_load_dword v99, v36, s[48:51], 0 offen offset:192 sc1
    buffer_load_dword v100, v36, s[48:51], 0 offen offset:256 sc1
    buffer_load_dword v101, v36, s[48:51], 0 offen offset:320 sc1
    buffer_load_dword v102, v36, s[48:51], 0 offen offset:384 sc1
    buffer_load_dword v103, v36, s[48:51], 0 offen offset:448 sc1
    s_waitcnt vmcnt(0)
    v_lshlrev_b32 v128, 16, v96
    v_and_b32 v129, s65, v96
    v_add_f32 v47, v47, v128
    v_add_f32 v43, v43, v129
    v_lshlrev_b32 v128, 16, v97
    v_and_b32 v129, s65, v97
    v_add_f32 v57, v57, v128
    v_add_f32 v53, v53, v129
    v_lshlrev_b32 v128, 16, v98
    v_and_b32 v129, s65, v98
    v_add_f32 v44, v44, v128
    v_add_f32 v40, v40, v129
    v_lshlrev_b32 v128, 16, v99
    v_and_b32 v129, s65, v99
    v_add_f32 v54, v54, v128
    v_add_f32 v50, v50, v129
    v_lshlrev_b32 v128, 16, v100
    v_and_b32 v129, s65, v100
    v_add_f32 v45, v45, v128
    v_add_f32 v41, v41, v129
    v_lshlrev_b32 v128, 16, v101
    v_and_b32 v129, s65, v101
    v_add_f32 v55, v55, v128
    v_add_f32 v51, v51, v129
    v_lshlrev_b32 v128, 16, v102
    v_and_b32 v129, s65, v102
    v_add_f32 v46, v46, v128
    v_add_f32 v42, v42, v129
    v_lshlrev_b32 v128, 16, v103
    v_and_b32 v129, s65, v103
    v_add_f32 v56, v56, v128
    v_add_f32 v52, v52, v129
    s_setpc_b64 s[6:7]
K2_DONE_123:
    s_cmp_eq_u32 s60, 0
    s_cbranch_scc1 K2_FIN_181
    s_bitcmp1_b32 s60, 0
    s_cbranch_scc1 K2_NEXT_182
    s_add_u32 s54, s54, 2048
    v_mov_b32 v32, 0xff
K2_NEXT_182:
    s_mov_b32 s76, 0
    s_waitcnt vmcnt(0) lgkmcnt(0)
    s_barrier
    s_cmp_ge_u32 s3, 4
    s_cbranch_scc1 K2_RB_183
    s_barrier
    s_barrier
    s_branch K2_X_28
K2_RB_183:
    v_add_u32 v45, s54, v0
    v_subrev_u32 v45, 256, v45
    v_lshlrev_b32 v45, 4, v45
    s_movk_i32 s70, 0
    buffer_load_dwordx4 v[52:55], v45, s[40:43], s70 offen sc1
    s_movk_i32 s70, 4096
    buffer_load_dwordx4 v[56:59], v45, s[40:43], s70 offen sc1
    s_movk_i32 s70, 8192
    buffer_load_dwordx4 v[60:63], v45, s[40:43], s70 offen sc1
    s_movk_i32 s70, 12288
    buffer_load_dwordx4 v[64:67], v45, s[40:43], s70 offen sc1
    s_movk_i32 s70, 16384
    buffer_load_dwordx4 v[68:71], v45, s[40:43], s70 offen sc1
    s_movk_i32 s70, 20480
    buffer_load_dwordx4 v[72:75], v45, s[40:43], s70 offen sc1
    s_movk_i32 s70, 24576
    buffer_load_dwordx4 v[76:79], v45, s[40:43], s70 offen sc1
    s_movk_i32 s70, 28672
    buffer_load_dwordx4 v[80:83], v45, s[40:43], s70 offen sc1
    v_mov_b32 v48, 0
    v_mov_b32 v49, 0
    v_mov_b32 v50, 0
    v_mov_b32 v51, 0xffff
    v_lshlrev_b32 v44, 4, v0
    v_add_u32 v44, 77824, v44
    ds_write_b128 v44, v[48:51] offset:0
    ds_write_b128 v44, v[48:51] offset:4096
    ds_write_b128 v44, v[48:51] offset:8192
    ds_write_b128 v44, v[48:51] offset:12288
    ds_write_b128 v44, v[48:51] offset:16384
    ds_write_b128 v44, v[48:51] offset:20480
    ds_write_b128 v44, v[48:51] offset:24576
    ds_write_b128 v44, v[48:51] offset:28672
    ds_write_b128 v44, v[48:51] offset:32768
    v_cmp_gt_u32 vcc, 320, v0
    s_and_b64 exec, exec, vcc
    ds_write_b128 v44, v[48:51] offset:36864
    s_mov_b64 exec, -1
    v_lshlrev_b32 v44, 3, v0
    v_add_u32 v44, 117760, v44
    v_cmp_gt_u32 vcc, 260, v0
    s_and_b64 exec, exec, vcc
    ds_write_b64 v44, v[48:49]
    s_mov_b64 exec, -1
    v_lshlrev_b32 v41, 3, v0
    v_add_u32 v41, 153600, v41
    v_mov_b32 v42, 0
    v_cmp_gt_u32 vcc, 456, v0
    s_and_b64 exec, exec, vcc
    ds_write2_b32 v41, v42, v42 offset0:0 offset1:1
    s_mov_b64 exec, -1
    s_waitcnt vmcnt(0) lgkmcnt(0)
    s_barrier
    s_branch K2_RANK_27
K2_FIN_181:
K1_END_6:
    s_endpgm
K1_SIDE_2:
    s_cmp_ge_u32 s2, 40
    s_cbranch_scc1 K1_LUT_8
    s_waitcnt lgkmcnt(0)
    s_mov_b32 s28, s8
    s_mov_b32 s29, s9
    s_mov_b32 s30, 640000
    s_mov_b32 s31, 0x20000
    s_mov_b32 s32, s10
    s_mov_b32 s33, s11
    s_mov_b32 s34, 640000
    s_mov_b32 s35, 0x20000
    s_mov_b32 s36, s6
    s_mov_b32 s37, s7
    s_mov_b32 s38, 60000
    s_mov_b32 s39, 0x20000
    s_mul_i32 s52, s2, 16000
    s_add_u32 s53, s52, 8000
    v_lshlrev_b32 v106, 4, v0
    v_mov_b32 v107, 0x7ffffff0
    v_cmp_gt_u32 vcc, 500, v0
    s_mov_b64 s[54:55], vcc
    s_nop 0
    v_cndmask_b32 v107, v107, v106, vcc
    buffer_load_dwordx4 v[2:5], v107, s[28:31], s52 offen
    buffer_load_dwordx4 v[10:13], v107, s[32:35], s52 offen
    buffer_load_dwordx4 v[6:9], v107, s[28:31], s53 offen
    buffer_load_dwordx4 v[14:17], v107, s[32:35], s53 offen
    v_mul_u32_u24 v110, 12, v0
    s_mov_b32 s57, 0
    buffer_load_dwordx3 v[118:120], v110, s[36:39], s57 offen
    s_mov_b32 s57, 6144
    buffer_load_dwordx3 v[122:124], v110, s[36:39], s57 offen
    s_mov_b32 s57, 12288
    buffer_load_dwordx3 v[126:128], v110, s[36:39], s57 offen
    s_mov_b32 s57, 18432
    buffer_load_dwordx3 v[130:132], v110, s[36:39], s57 offen
    s_mov_b32 s57, 24576
    buffer_load_dwordx3 v[134:136], v110, s[36:39], s57 offen
    s_mov_b32 s57, 30720
    buffer_load_dwordx3 v[138:140], v110, s[36:39], s57 offen
    s_mov_b32 s57, 36864
    buffer_load_dwordx3 v[142:144], v110, s[36:39], s57 offen
    s_mov_b32 s57, 43008
    buffer_load_dwordx3 v[146:148], v110, s[36:39], s57 offen
    s_mov_b32 s57, 49152
    buffer_load_dwordx3 v[150:152], v110, s[36:39], s57 offen
    s_mov_b32 s57, 55296
    buffer_load_dwordx3 v[154:156], v110, s[36:39], s57 offen
    s_mov_b32 s40, s22
    s_mov_b32 s41, s23
    s_mov_b32 s42, 256
    s_mov_b32 s43, 0x20000
    s_add_u32 s44, s24, 27262976
    s_addc_u32 s45, s25, 0
    s_mov_b32 s46, 164364288
    s_mov_b32 s47, 0x20000
    s_add_u32 s48, s24, 25600000
    s_addc_u32 s49, s25, 0
    s_mov_b32 s50, 142080
    s_mov_b32 s51, 0x20000
    v_mov_b32 v108, 0
    v_lshlrev_b32 v109, 2, v0
    v_add_u32 v109, 81920, v109
    v_cmp_gt_u32 vcc, 64, v0
    s_and_saveexec_b64 s[58:59], vcc
    ds_write_b32 v109, v108
    s_mov_b64 exec, -1
    s_mov_b32 s56, 0x322bcc77
    s_mov_b32 s57, 0x322bcc77
    s_mov_b32 s53, 0xffff0000
    s_mov_b32 s58, 1050673152
    v_mov_b32 v114, 3277848576
    v_mov_b32 v115, 1199570944
    v_mov_b32 v116, 160
    v_mov_b32 v117, 1
    s_waitcnt vmcnt(10)
    v_cmp_le_u32 vcc, 5000, v2
    v_lshlrev_b32 v66, 3, v2
    v_lshlrev_b32 v74, 3, v10
    v_cndmask_b32 v110, 0, v116, vcc
    v_lshrrev_b32 v158, 6, v10
    v_and_b32 v10, 63, v10
    v_add_u32 v158, v158, v110
    v_lshlrev_b32 v10, 2, v10
    v_add_u32 v166, 81920, v10
    v_cmp_le_u32 vcc, 5000, v3
    v_lshlrev_b32 v67, 3, v3
    v_lshlrev_b32 v75, 3, v11
    v_cndmask_b32 v110, 0, v116, vcc
    v_lshrrev_b32 v159, 6, v11
    v_and_b32 v11, 63, v11
    v_add_u32 v159, v159, v110
    v_lshlrev_b32 v11, 2, v11
    v_add_u32 v167, 81920, v11
    v_cmp_le_u32 vcc, 5000, v4
    v_lshlrev_b32 v68, 3, v4
    v_lshlrev_b32 v76, 3, v12
    v_cndmask_b32 v110, 0, v116, vcc
    v_lshrrev_b32 v160, 6, v12
    v_and_b32 v12, 63, v12
    v_add_u32 v160, v160, v110
    v_lshlrev_b32 v12, 2, v12
    v_add_u32 v168, 81920, v12
    v_cmp_le_u32 vcc, 5000, v5
    v_lshlrev_b32 v69, 3, v5
    v_lshlrev_b32 v77, 3, v13
    v_cndmask_b32 v110, 0, v116, vcc
    v_lshrrev_b32 v161, 6, v13
    v_and_b32 v13, 63, v13
    v_add_u32 v161, v161, v110
    v_lshlrev_b32 v13, 2, v13
    v_add_u32 v169, 81920, v13
    v_cmp_le_u32 vcc, 5000, v6
    v_lshlrev_b32 v70, 3, v6
    v_lshlrev_b32 v78, 3, v14
    v_cndmask_b32 v110, 0, v116, vcc
    v_lshrrev_b32 v162, 6, v14
    v_and_b32 v14, 63, v14
    v_add_u32 v162, v162, v110
    v_lshlrev_b32 v14, 2, v14
    v_add_u32 v170, 81920, v14
    v_cmp_le_u32 vcc, 5000, v7
    v_lshlrev_b32 v71, 3, v7
    v_lshlrev_b32 v79, 3, v15
    v_cndmask_b32 v110, 0, v116, vcc
    v_lshrrev_b32 v163, 6, v15
    v_and_b32 v15, 63, v15
    v_add_u32 v163, v163, v110
    v_lshlrev_b32 v15, 2, v15
    v_add_u32 v171, 81920, v15
    v_cmp_le_u32 vcc, 5000, v8
    v_lshlrev_b32 v72, 3, v8
    v_lshlrev_b32 v80, 3, v16
    v_cndmask_b32 v110, 0, v116, vcc
    v_lshrrev_b32 v164, 6, v16
    v_and_b32 v16, 63, v16
    v_add_u32 v164, v164, v110
    v_lshlrev_b32 v16, 2, v16
    v_add_u32 v172, 81920, v16
    v_cmp_le_u32 vcc, 5000, v9
    v_lshlrev_b32 v73, 3, v9
    v_lshlrev_b32 v81, 3, v17
    v_cndmask_b32 v110, 0, v116, vcc
    v_lshrrev_b32 v165, 6, v17
    v_and_b32 v17, 63, v17
    v_add_u32 v165, v165, v110
    v_lshlrev_b32 v17, 2, v17
    v_add_u32 v173, 81920, v17
    v_add_u32 v110, 65536, v106
    s_waitcnt vmcnt(9)
    v_and_b32 v121, s53, v120
    v_alignbit_b32 v120, v120, v119, 16
    v_lshlrev_b32 v119, 16, v119
    ds_write_b128 v106, v[118:121] offset:0
    s_waitcnt vmcnt(8)
    v_and_b32 v125, s53, v124
    v_alignbit_b32 v124, v124, v123, 16
    v_lshlrev_b32 v123, 16, v123
    ds_write_b128 v106, v[122:125] offset:8192
    s_waitcnt vmcnt(7)
    v_and_b32 v129, s53, v128
    v_alignbit_b32 v128, v128, v127, 16
    v_lshlrev_b32 v127, 16, v127
    ds_write_b128 v106, v[126:129] offset:16384
    s_waitcnt vmcnt(6)
    v_and_b32 v133, s53, v132
    v_alignbit_b32 v132, v132, v131, 16
    v_lshlrev_b32 v131, 16, v131
    ds_write_b128 v106, v[130:133] offset:24576
    s_waitcnt vmcnt(5)
    v_and_b32 v137, s53, v136
    v_alignbit_b32 v136, v136, v135, 16
    v_lshlrev_b32 v135, 16, v135
    ds_write_b128 v106, v[134:137] offset:32768
    s_waitcnt vmcnt(4)
    v_and_b32 v141, s53, v140
    v_alignbit_b32 v140, v140, v139, 16
    v_lshlrev_b32 v139, 16, v139
    ds_write_b128 v106, v[138:141] offset:40960
    s_waitcnt vmcnt(3)
    v_and_b32 v145, s53, v144
    v_alignbit_b32 v144, v144, v143, 16
    v_lshlrev_b32 v143, 16, v143
    ds_write_b128 v106, v[142:145] offset:49152
    s_waitcnt vmcnt(2)
    v_and_b32 v149, s53, v148
    v_alignbit_b32 v148, v148, v147, 16
    v_lshlrev_b32 v147, 16, v147
    ds_write_b128 v106, v[146:149] offset:57344
    s_waitcnt vmcnt(1)
    v_and_b32 v153, s53, v152
    v_alignbit_b32 v152, v152, v151, 16
    v_lshlrev_b32 v151, 16, v151
    ds_write_b128 v110, v[150:153] offset:0
    s_waitcnt vmcnt(0)
    v_and_b32 v157, s53, v156
    v_alignbit_b32 v156, v156, v155, 16
    v_lshlrev_b32 v155, 16, v155
    ds_write_b128 v110, v[154:157] offset:8192
    s_waitcnt lgkmcnt(0)
    s_barrier
    ds_read_b64 v[118:119], v66 offset:0
    ds_read_b64 v[120:121], v74 offset:0
    ds_read_b64 v[122:123], v67 offset:0
    ds_read_b64 v[124:125], v75 offset:0
    ds_read_b64 v[126:127], v68 offset:0
    ds_read_b64 v[128:129], v76 offset:0
    ds_read_b64 v[130:131], v69 offset:0
    ds_read_b64 v[132:133], v77 offset:0
    ds_read_b64 v[134:135], v70 offset:0
    ds_read_b64 v[136:137], v78 offset:0
    ds_read_b64 v[138:139], v71 offset:0
    ds_read_b64 v[140:141], v79 offset:0
    s_waitcnt lgkmcnt(8)
    ds_read_b64 v[142:143], v72 offset:0
    ds_read_b64 v[144:145], v80 offset:0
    ds_read_b64 v[146:147], v73 offset:0
    ds_read_b64 v[148:149], v81 offset:0
    v_lshlrev_b32 v18, 16, v118
    v_lshlrev_b32 v24, 16, v120
    v_and_b32 v20, s53, v118
    v_and_b32 v26, s53, v120
    v_sub_f32 v22, v119, v121
    v_lshlrev_b32 v19, 16, v122
    v_lshlrev_b32 v25, 16, v124
    v_and_b32 v21, s53, v122
    v_and_b32 v27, s53, v124
    v_sub_f32 v23, v123, v125
    v_pk_add_f32 v[18:19], v[18:19], v[24:25] neg_lo:[0,1] neg_hi:[0,1]
    v_pk_add_f32 v[20:21], v[20:21], v[26:27] neg_lo:[0,1] neg_hi:[0,1]
    v_cvt_pk_bf16_f32 v110, v18, v19
    v_lshlrev_b32 v18, 16, v110
    v_and_b32 v19, s53, v110
    v_cvt_pk_bf16_f32 v111, v20, v21
    v_lshlrev_b32 v20, 16, v111
    v_and_b32 v21, s53, v111
    v_cvt_pk_bf16_f32 v112, v22, v23
    v_lshlrev_b32 v22, 16, v112
    v_and_b32 v23, s53, v112
    v_pk_mul_f32 v[24:25], v[18:19], v[18:19]
    v_pk_mul_f32 v[26:27], v[20:21], v[20:21]
    v_pk_mul_f32 v[28:29], v[22:23], v[22:23]
    v_cvt_pk_bf16_f32 v110, v24, v25
    v_lshlrev_b32 v24, 16, v110
    v_and_b32 v25, s53, v110
    v_cvt_pk_bf16_f32 v111, v26, v27
    v_lshlrev_b32 v26, 16, v111
    v_and_b32 v27, s53, v111
    v_cvt_pk_bf16_f32 v112, v28, v29
    v_lshlrev_b32 v28, 16, v112
    v_and_b32 v29, s53, v112
    v_pk_add_f32 v[24:25], v[24:25], v[26:27]
    v_pk_add_f32 v[24:25], v[24:25], v[28:29]
    v_cvt_pk_bf16_f32 v110, v24, v25
    v_lshlrev_b32 v24, 16, v110
    v_and_b32 v25, s53, v110
    v_pk_add_f32 v[24:25], v[24:25], s[56:57]
    v_cvt_pk_bf16_f32 v110, v24, v25
    v_lshlrev_b32 v24, 16, v110
    v_and_b32 v25, s53, v110
    v_sqrt_f32 v24, v24
    v_sqrt_f32 v25, v25
    s_nop 0
    v_cvt_pk_bf16_f32 v110, v24, v25
    v_lshlrev_b32 v174, 16, v110
    v_and_b32 v175, s53, v110
    v_cmp_gt_u32 vcc, 1084030976, v174
    s_and_b64 s[60:61], vcc, s[54:55]
    s_mov_b64 exec, s[60:61]
    ds_add_rtn_u32 v98, v166, v117
    s_mov_b64 exec, -1
    v_cmp_gt_u32 vcc, 1084030976, v175
    s_and_b64 s[62:63], vcc, s[54:55]
    s_mov_b64 exec, s[62:63]
    ds_add_rtn_u32 v99, v167, v117
    s_mov_b64 exec, -1
    s_waitcnt lgkmcnt(8)
    v_lshlrev_b32 v30, 16, v126
    v_lshlrev_b32 v36, 16, v128
    v_and_b32 v32, s53, v126
    v_and_b32 v38, s53, v128
    v_sub_f32 v34, v127, v129
    v_lshlrev_b32 v31, 16, v130
    v_lshlrev_b32 v37, 16, v132
    v_and_b32 v33, s53, v130
    v_and_b32 v39, s53, v132
    v_sub_f32 v35, v131, v133
    v_pk_add_f32 v[30:31], v[30:31], v[36:37] neg_lo:[0,1] neg_hi:[0,1]
    v_pk_add_f32 v[32:33], v[32:33], v[38:39] neg_lo:[0,1] neg_hi:[0,1]
    v_cvt_pk_bf16_f32 v110, v30, v31
    v_lshlrev_b32 v30, 16, v110
    v_and_b32 v31, s53, v110
    v_cvt_pk_bf16_f32 v111, v32, v33
    v_lshlrev_b32 v32, 16, v111
    v_and_b32 v33, s53, v111
    v_cvt_pk_bf16_f32 v112, v34, v35
    v_lshlrev_b32 v34, 16, v112
    v_and_b32 v35, s53, v112
    v_pk_mul_f32 v[36:37], v[30:31], v[30:31]
    v_pk_mul_f32 v[38:39], v[32:33], v[32:33]
    v_pk_mul_f32 v[40:41], v[34:35], v[34:35]
    v_cvt_pk_bf16_f32 v110, v36, v37
    v_lshlrev_b32 v36, 16, v110
    v_and_b32 v37, s53, v110
    v_cvt_pk_bf16_f32 v111, v38, v39
    v_lshlrev_b32 v38, 16, v111
    v_and_b32 v39, s53, v111
    v_cvt_pk_bf16_f32 v112, v40, v41
    v_lshlrev_b32 v40, 16, v112
    v_and_b32 v41, s53, v112
    v_pk_add_f32 v[36:37], v[36:37], v[38:39]
    v_pk_add_f32 v[36:37], v[36:37], v[40:41]
    v_cvt_pk_bf16_f32 v110, v36, v37
    v_lshlrev_b32 v36, 16, v110
    v_and_b32 v37, s53, v110
    v_pk_add_f32 v[36:37], v[36:37], s[56:57]
    v_cvt_pk_bf16_f32 v110, v36, v37
    v_lshlrev_b32 v36, 16, v110
    v_and_b32 v37, s53, v110
    v_sqrt_f32 v36, v36
    v_sqrt_f32 v37, v37
    s_nop 0
    v_cvt_pk_bf16_f32 v110, v36, v37
    v_lshlrev_b32 v176, 16, v110
    v_and_b32 v177, s53, v110
    v_cmp_gt_u32 vcc, 1084030976, v176
    s_and_b64 s[64:65], vcc, s[54:55]
    s_mov_b64 exec, s[64:65]
    ds_add_rtn_u32 v100, v168, v117
    s_mov_b64 exec, -1
    v_cmp_gt_u32 vcc, 1084030976, v177
    s_and_b64 s[66:67], vcc, s[54:55]
    s_mov_b64 exec, s[66:67]
    ds_add_rtn_u32 v101, v169, v117
    s_mov_b64 exec, -1
    s_waitcnt lgkmcnt(4)
    v_lshlrev_b32 v42, 16, v134
    v_lshlrev_b32 v48, 16, v136
    v_and_b32 v44, s53, v134
    v_and_b32 v50, s53, v136
    v_sub_f32 v46, v135, v137
    v_lshlrev_b32 v43, 16, v138
    v_lshlrev_b32 v49, 16, v140
    v_and_b32 v45, s53, v138
    v_and_b32 v51, s53, v140
    v_sub_f32 v47, v139, v141
    v_pk_add_f32 v[42:43], v[42:43], v[48:49] neg_lo:[0,1] neg_hi:[0,1]
    v_pk_add_f32 v[44:45], v[44:45], v[50:51] neg_lo:[0,1] neg_hi:[0,1]
    v_cvt_pk_bf16_f32 v110, v42, v43
    v_lshlrev_b32 v42, 16, v110
    v_and_b32 v43, s53, v110
    v_cvt_pk_bf16_f32 v111, v44, v45
    v_lshlrev_b32 v44, 16, v111
    v_and_b32 v45, s53, v111
    v_cvt_pk_bf16_f32 v112, v46, v47
    v_lshlrev_b32 v46, 16, v112
    v_and_b32 v47, s53, v112
    v_pk_mul_f32 v[48:49], v[42:43], v[42:43]
    v_pk_mul_f32 v[50:51], v[44:45], v[44:45]
    v_pk_mul_f32 v[52:53], v[46:47], v[46:47]
    v_cvt_pk_bf16_f32 v110, v48, v49
    v_lshlrev_b32 v48, 16, v110
    v_and_b32 v49, s53, v110
    v_cvt_pk_bf16_f32 v111, v50, v51
    v_lshlrev_b32 v50, 16, v111
    v_and_b32 v51, s53, v111
    v_cvt_pk_bf16_f32 v112, v52, v53
    v_lshlrev_b32 v52, 16, v112
    v_and_b32 v53, s53, v112
    v_pk_add_f32 v[48:49], v[48:49], v[50:51]
    v_pk_add_f32 v[48:49], v[48:49], v[52:53]
    v_cvt_pk_bf16_f32 v110, v48, v49
    v_lshlrev_b32 v48, 16, v110
    v_and_b32 v49, s53, v110
    v_pk_add_f32 v[48:49], v[48:49], s[56:57]
    v_cvt_pk_bf16_f32 v110, v48, v49
    v_lshlrev_b32 v48, 16, v110
    v_and_b32 v49, s53, v110
    v_sqrt_f32 v48, v48
    v_sqrt_f32 v49, v49
    s_nop 0
    v_cvt_pk_bf16_f32 v110, v48, v49
    v_lshlrev_b32 v178, 16, v110
    v_and_b32 v179, s53, v110
    v_cmp_gt_u32 vcc, 1084030976, v178
    s_and_b64 s[68:69], vcc, s[54:55]
    s_mov_b64 exec, s[68:69]
    ds_add_rtn_u32 v102, v170, v117
    s_mov_b64 exec, -1
    v_cmp_gt_u32 vcc, 1084030976, v179
    s_and_b64 s[70:71], vcc, s[54:55]
    s_mov_b64 exec, s[70:71]
    ds_add_rtn_u32 v103, v171, v117
    s_mov_b64 exec, -1
    s_waitcnt lgkmcnt(0)
    v_lshlrev_b32 v54, 16, v142
    v_lshlrev_b32 v60, 16, v144
    v_and_b32 v56, s53, v142
    v_and_b32 v62, s53, v144
    v_sub_f32 v58, v143, v145
    v_lshlrev_b32 v55, 16, v146
    v_lshlrev_b32 v61, 16, v148
    v_and_b32 v57, s53, v146
    v_and_b32 v63, s53, v148
    v_sub_f32 v59, v147, v149
    v_pk_add_f32 v[54:55], v[54:55], v[60:61] neg_lo:[0,1] neg_hi:[0,1]
    v_pk_add_f32 v[56:57], v[56:57], v[62:63] neg_lo:[0,1] neg_hi:[0,1]
    v_cvt_pk_bf16_f32 v110, v54, v55
    v_lshlrev_b32 v54, 16, v110
    v_and_b32 v55, s53, v110
    v_cvt_pk_bf16_f32 v111, v56, v57
    v_lshlrev_b32 v56, 16, v111
    v_and_b32 v57, s53, v111
    v_cvt_pk_bf16_f32 v112, v58, v59
    v_lshlrev_b32 v58, 16, v112
    v_and_b32 v59, s53, v112
    v_pk_mul_f32 v[60:61], v[54:55], v[54:55]
    v_pk_mul_f32 v[62:63], v[56:57], v[56:57]
    v_pk_mul_f32 v[64:65], v[58:59], v[58:59]
    v_cvt_pk_bf16_f32 v110, v60, v61
    v_lshlrev_b32 v60, 16, v110
    v_and_b32 v61, s53, v110
    v_cvt_pk_bf16_f32 v111, v62, v63
    v_lshlrev_b32 v62, 16, v111
    v_and_b32 v63, s53, v111
    v_cvt_pk_bf16_f32 v112, v64, v65
    v_lshlrev_b32 v64, 16, v112
    v_and_b32 v65, s53, v112
    v_pk_add_f32 v[60:61], v[60:61], v[62:63]
    v_pk_add_f32 v[60:61], v[60:61], v[64:65]
    v_cvt_pk_bf16_f32 v110, v60, v61
    v_lshlrev_b32 v60, 16, v110
    v_and_b32 v61, s53, v110
    v_pk_add_f32 v[60:61], v[60:61], s[56:57]
    v_cvt_pk_bf16_f32 v110, v60, v61
    v_lshlrev_b32 v60, 16, v110
    v_and_b32 v61, s53, v110
    v_sqrt_f32 v60, v60
    v_sqrt_f32 v61, v61
    s_nop 0
    v_cvt_pk_bf16_f32 v110, v60, v61
    v_lshlrev_b32 v180, 16, v110
    v_and_b32 v181, s53, v110
    v_cmp_gt_u32 vcc, 1084030976, v180
    s_and_b64 s[72:73], vcc, s[54:55]
    s_mov_b64 exec, s[72:73]
    ds_add_rtn_u32 v104, v172, v117
    s_mov_b64 exec, -1
    v_cmp_gt_u32 vcc, 1084030976, v181
    s_and_b64 s[74:75], vcc, s[54:55]
    s_mov_b64 exec, s[74:75]
    ds_add_rtn_u32 v105, v173, v117
    s_mov_b64 exec, -1
    s_waitcnt lgkmcnt(0)
    s_barrier
    s_cmp_lg_u32 s3, 0
    s_cbranch_scc1 K1_NOATOM_10
    ds_read_b32 v186, v109
    v_lshlrev_b32 v111, 2, v0
    s_waitcnt lgkmcnt(0)
    v_mov_b32 v187, v186
    v_add_u32 v186, 3, v186
    v_and_b32 v186, -4, v186
    v_mov_b32 v188, v186
    v_mov_b32 v189, v186
    buffer_atomic_add v188, v111, s[40:43], 0 offen sc0
    s_nop 1
    v_add_u32_dpp v189, v189, v189 row_shr:1 row_mask:0xf bank_mask:0xf bound_ctrl:0
    s_nop 1
    v_add_u32_dpp v189, v189, v189 row_shr:2 row_mask:0xf bank_mask:0xf bound_ctrl:0
    s_nop 1
    v_add_u32_dpp v189, v189, v189 row_shr:4 row_mask:0xf bank_mask:0xf bound_ctrl:0
    s_nop 1
    v_add_u32_dpp v189, v189, v189 row_shr:8 row_mask:0xf bank_mask:0xf bound_ctrl:0
    s_nop 1
    v_add_u32_dpp v189, v189, v189 row_bcast:15 row_mask:0xa bank_mask:0xf
    s_nop 1
    v_add_u32_dpp v189, v189, v189 row_bcast:31 row_mask:0xc bank_mask:0xf
    ds_write_b32 v109, v189 offset:4
    v_sub_u32 v189, v189, v186
    ds_write_b32 v109, v189
    v_mov_b32 v118, 0xffff
    v_mov_b32 v119, v111
    v_mov_b32 v120, 0
    v_mov_b32 v121, 0
    v_add_lshl_u32 v122, v189, v187, 4
    v_sub_u32 v187, v186, v187
    v_cmp_lt_u32 vcc, 0, v187
    s_and_b64 exec, exec, vcc
    ds_write_b128 v122, v[118:121] offset:0
    v_cmp_lt_u32 vcc, 1, v187
    s_and_b64 exec, exec, vcc
    ds_write_b128 v122, v[118:121] offset:16
    v_cmp_lt_u32 vcc, 2, v187
    s_and_b64 exec, exec, vcc
    ds_write_b128 v122, v[118:121] offset:32
    s_mov_b64 exec, -1
K1_NOATOM_10:
    v_rcp_f32 v182, v174
    v_rcp_f32 v183, v175
    v_cmp_gt_u32 vcc, s58, v174
    v_cmp_gt_u32 s[56:57], s58, v175
    v_pk_mul_f32 v[18:19], v[18:19], v[182:183]
    v_pk_mul_f32 v[20:21], v[20:21], v[182:183]
    v_pk_mul_f32 v[22:23], v[22:23], v[182:183]
    v_cndmask_b32 v184, v114, v115, vcc
    v_cndmask_b32 v185, v114, v115, s[56:57]
    v_cvt_pk_bf16_f32 v110, v18, v19
    v_cvt_pk_bf16_f32 v111, v20, v21
    v_cvt_pk_bf16_f32 v112, v22, v23
    v_add3_u32 v69, v174, v184, v2
    v_add3_u32 v73, v175, v185, v3
    v_lshl_or_b32 v66, v110, 16, v158
    v_and_or_b32 v70, v110, s53, v159
    v_lshl_or_b32 v67, v111, 16, v10
    v_and_or_b32 v71, v111, s53, v11
    v_lshlrev_b32 v68, 16, v112
    v_and_b32 v72, s53, v112
    v_rcp_f32 v182, v176
    v_rcp_f32 v183, v177
    v_cmp_gt_u32 vcc, s58, v176
    v_cmp_gt_u32 s[56:57], s58, v177
    v_pk_mul_f32 v[30:31], v[30:31], v[182:183]
    v_pk_mul_f32 v[32:33], v[32:33], v[182:183]
    v_pk_mul_f32 v[34:35], v[34:35], v[182:183]
    v_cndmask_b32 v184, v114, v115, vcc
    v_cndmask_b32 v185, v114, v115, s[56:57]
    v_cvt_pk_bf16_f32 v110, v30, v31
    v_cvt_pk_bf16_f32 v111, v32, v33
    v_cvt_pk_bf16_f32 v112, v34, v35
    v_add3_u32 v77, v176, v184, v4
    v_add3_u32 v81, v177, v185, v5
    v_lshl_or_b32 v74, v110, 16, v160
    v_and_or_b32 v78, v110, s53, v161
    v_lshl_or_b32 v75, v111, 16, v12
    v_and_or_b32 v79, v111, s53, v13
    v_lshlrev_b32 v76, 16, v112
    v_and_b32 v80, s53, v112
    v_rcp_f32 v182, v178
    v_rcp_f32 v183, v179
    v_cmp_gt_u32 vcc, s58, v178
    v_cmp_gt_u32 s[56:57], s58, v179
    v_pk_mul_f32 v[42:43], v[42:43], v[182:183]
    v_pk_mul_f32 v[44:45], v[44:45], v[182:183]
    v_pk_mul_f32 v[46:47], v[46:47], v[182:183]
    v_cndmask_b32 v184, v114, v115, vcc
    v_cndmask_b32 v185, v114, v115, s[56:57]
    v_cvt_pk_bf16_f32 v110, v42, v43
    v_cvt_pk_bf16_f32 v111, v44, v45
    v_cvt_pk_bf16_f32 v112, v46, v47
    v_add3_u32 v85, v178, v184, v6
    v_add3_u32 v89, v179, v185, v7
    v_lshl_or_b32 v82, v110, 16, v162
    v_and_or_b32 v86, v110, s53, v163
    v_lshl_or_b32 v83, v111, 16, v14
    v_and_or_b32 v87, v111, s53, v15
    v_lshlrev_b32 v84, 16, v112
    v_and_b32 v88, s53, v112
    v_rcp_f32 v182, v180
    v_rcp_f32 v183, v181
    v_cmp_gt_u32 vcc, s58, v180
    v_cmp_gt_u32 s[56:57], s58, v181
    v_pk_mul_f32 v[54:55], v[54:55], v[182:183]
    v_pk_mul_f32 v[56:57], v[56:57], v[182:183]
    v_pk_mul_f32 v[58:59], v[58:59], v[182:183]
    v_cndmask_b32 v184, v114, v115, vcc
    v_cndmask_b32 v185, v114, v115, s[56:57]
    v_cvt_pk_bf16_f32 v110, v54, v55
    v_cvt_pk_bf16_f32 v111, v56, v57
    v_cvt_pk_bf16_f32 v112, v58, v59
    v_add3_u32 v93, v180, v184, v8
    v_add3_u32 v97, v181, v185, v9
    v_lshl_or_b32 v90, v110, 16, v164
    v_and_or_b32 v94, v110, s53, v165
    v_lshl_or_b32 v91, v111, 16, v16
    v_and_or_b32 v95, v111, s53, v17
    v_lshlrev_b32 v92, 16, v112
    v_and_b32 v96, s53, v112
    s_waitcnt lgkmcnt(0)
    s_barrier
    ds_read_b32 v18, v166
    ds_read_b32 v19, v167
    ds_read_b32 v20, v168
    ds_read_b32 v21, v169
    ds_read_b32 v22, v170
    ds_read_b32 v23, v171
    ds_read_b32 v24, v172
    ds_read_b32 v25, v173
    v_mov_b32 v114, 81920
    ds_read_b32 v115, v114 offset:256
    s_waitcnt lgkmcnt(0)
    v_add_lshl_u32 v18, v18, v98, 4
    v_add_u32 v18, 0, v18
    s_mov_b64 exec, s[60:61]
    ds_write_b128 v18, v[66:69]
    s_mov_b64 exec, -1
    v_add_lshl_u32 v19, v19, v99, 4
    v_add_u32 v19, 0, v19
    s_mov_b64 exec, s[62:63]
    ds_write_b128 v19, v[70:73]
    s_mov_b64 exec, -1
    v_add_lshl_u32 v20, v20, v100, 4
    v_add_u32 v20, 0, v20
    s_mov_b64 exec, s[64:65]
    ds_write_b128 v20, v[74:77]
    s_mov_b64 exec, -1
    v_add_lshl_u32 v21, v21, v101, 4
    v_add_u32 v21, 0, v21
    s_mov_b64 exec, s[66:67]
    ds_write_b128 v21, v[78:81]
    s_mov_b64 exec, -1
    v_add_lshl_u32 v22, v22, v102, 4
    v_add_u32 v22, 0, v22
    s_mov_b64 exec, s[68:69]
    ds_write_b128 v22, v[82:85]
    s_mov_b64 exec, -1
    v_add_lshl_u32 v23, v23, v103, 4
    v_add_u32 v23, 0, v23
    s_mov_b64 exec, s[70:71]
    ds_write_b128 v23, v[86:89]
    s_mov_b64 exec, -1
    v_add_lshl_u32 v24, v24, v104, 4
    v_add_u32 v24, 0, v24
    s_mov_b64 exec, s[72:73]
    ds_write_b128 v24, v[90:93]
    s_mov_b64 exec, -1
    v_add_lshl_u32 v25, v25, v105, 4
    v_add_u32 v25, 0, v25
    s_mov_b64 exec, s[74:75]
    ds_write_b128 v25, v[94:97]
    s_mov_b64 exec, -1
    v_readfirstlane_b32 s56, v115
    s_cmp_lg_u32 s3, 0
    s_cbranch_scc1 K1_NOATOM2_11
    s_mov_b32 s52, 160512
    s_waitcnt vmcnt(0)
    v_and_b32 v188, 0x3ffff, v188
    v_mad_u32_u24 v112, v0, s52, v188
    v_sub_u32 v112, v112, v189
    v_lshlrev_b32 v112, 4, v112
    ds_write_b32 v109, v112 offset:512
K1_NOATOM2_11:
    v_lshlrev_b32 v111, 4, v0
    v_add_u32 v108, 0, v111
    s_waitcnt lgkmcnt(0)
    s_barrier
    ds_read_b128 v[66:69], v108 offset:0
    ds_read_b128 v[70:73], v108 offset:8192
    ds_read_b128 v[74:77], v108 offset:16384
    ds_read_b128 v[78:81], v108 offset:24576
    ds_read_b128 v[82:85], v108 offset:32768
    ds_read_b128 v[86:89], v108 offset:40960
    s_waitcnt lgkmcnt(5)
    v_and_b32 v18, 0xfc, v67
    v_add_u32 v18, 82432, v18
    ds_read_b32 v18, v18
    v_and_b32 v67, s53, v67
    v_add_u32 v112, 0, v0
    v_cmp_gt_u32 s[60:61], s56, v112
    s_waitcnt lgkmcnt(5)
    v_and_b32 v19, 0xfc, v71
    v_add_u32 v19, 82432, v19
    ds_read_b32 v19, v19
    v_and_b32 v71, s53, v71
    v_add_u32 v112, 512, v0
    v_cmp_gt_u32 s[62:63], s56, v112
    s_waitcnt lgkmcnt(5)
    v_and_b32 v20, 0xfc, v75
    v_add_u32 v20, 82432, v20
    ds_read_b32 v20, v20
    v_and_b32 v75, s53, v75
    v_add_u32 v112, 1024, v0
    v_cmp_gt_u32 s[64:65], s56, v112
    s_waitcnt lgkmcnt(5)
    v_and_b32 v21, 0xfc, v79
    v_add_u32 v21, 82432, v21
    ds_read_b32 v21, v21
    v_and_b32 v79, s53, v79
    v_add_u32 v112, 1536, v0
    v_cmp_gt_u32 s[66:67], s56, v112
    s_waitcnt lgkmcnt(5)
    v_and_b32 v22, 0xfc, v83
    v_add_u32 v22, 82432, v22
    ds_read_b32 v22, v22
    v_and_b32 v83, s53, v83
    v_add_u32 v112, 2048, v0
    v_cmp_gt_u32 s[68:69], s56, v112
    s_waitcnt lgkmcnt(5)
    v_and_b32 v23, 0xfc, v87
    v_add_u32 v23, 82432, v23
    ds_read_b32 v23, v23
    v_and_b32 v87, s53, v87
    v_add_u32 v112, 2560, v0
    v_cmp_gt_u32 s[70:71], s56, v112
    s_waitcnt lgkmcnt(5)
    v_add_u32 v18, v18, v111
    s_mov_b32 s52, 0
    s_mov_b64 exec, s[60:61]
    s_cbranch_execz K1_ES_12
    buffer_store_dwordx4 v[66:69], v18, s[44:47], s52 offen sc1
K1_ES_12:
    s_mov_b64 exec, -1
    s_waitcnt lgkmcnt(4)
    v_add_u32 v19, v19, v111
    s_mov_b32 s52, 8192
    s_mov_b64 exec, s[62:63]
    s_cbranch_execz K1_ES_13
    buffer_store_dwordx4 v[70:73], v19, s[44:47], s52 offen sc1
K1_ES_13:
    s_mov_b64 exec, -1
    s_waitcnt lgkmcnt(3)
    v_add_u32 v20, v20, v111
    s_mov_b32 s52, 16384
    s_mov_b64 exec, s[64:65]
    s_cbranch_execz K1_ES_14
    buffer_store_dwordx4 v[74:77], v20, s[44:47], s52 offen sc1
K1_ES_14:
    s_mov_b64 exec, -1
    s_waitcnt lgkmcnt(2)
    v_add_u32 v21, v21, v111
    s_mov_b32 s52, 24576
    s_mov_b64 exec, s[66:67]
    s_cbranch_execz K1_ES_15
    buffer_store_dwordx4 v[78:81], v21, s[44:47], s52 offen sc1
K1_ES_15:
    s_mov_b64 exec, -1
    s_waitcnt lgkmcnt(1)
    v_add_u32 v22, v22, v111
    s_mov_b32 s52, 32768
    s_mov_b64 exec, s[68:69]
    s_cbranch_execz K1_ES_16
    buffer_store_dwordx4 v[82:85], v22, s[44:47], s52 offen sc1
K1_ES_16:
    s_mov_b64 exec, -1
    s_waitcnt lgkmcnt(0)
    v_add_u32 v23, v23, v111
    s_mov_b32 s52, 40960
    s_mov_b64 exec, s[70:71]
    s_cbranch_execz K1_ES_17
    buffer_store_dwordx4 v[86:89], v23, s[44:47], s52 offen sc1
K1_ES_17:
    s_mov_b64 exec, -1
    s_cmp_le_u32 s56, 3072
    s_cbranch_scc1 K1_CO_18
    v_add_u32 v108, 49152, v108
    s_nop 1
    ds_read_b128 v[66:69], v108 offset:0
    ds_read_b128 v[70:73], v108 offset:8192
    ds_read_b128 v[74:77], v108 offset:16384
    s_waitcnt lgkmcnt(2)
    v_and_b32 v18, 0xfc, v67
    v_add_u32 v18, 82432, v18
    ds_read_b32 v18, v18
    v_and_b32 v67, s53, v67
    v_add_u32 v112, 3072, v0
    v_cmp_gt_u32 s[60:61], s56, v112
    s_waitcnt lgkmcnt(2)
    v_and_b32 v19, 0xfc, v71
    v_add_u32 v19, 82432, v19
    ds_read_b32 v19, v19
    v_and_b32 v71, s53, v71
    v_add_u32 v112, 3584, v0
    v_cmp_gt_u32 s[62:63], s56, v112
    s_waitcnt lgkmcnt(2)
    v_and_b32 v20, 0xfc, v75
    v_add_u32 v20, 82432, v20
    ds_read_b32 v20, v20
    v_and_b32 v75, s53, v75
    v_add_u32 v112, 4096, v0
    v_cmp_gt_u32 s[64:65], s56, v112
    s_waitcnt lgkmcnt(2)
    v_add_u32 v18, v18, v111
    s_mov_b32 s52, 49152
    s_mov_b64 exec, s[60:61]
    s_cbranch_execz K1_ES_19
    buffer_store_dwordx4 v[66:69], v18, s[44:47], s52 offen sc1
K1_ES_19:
    s_mov_b64 exec, -1
    s_waitcnt lgkmcnt(1)
    v_add_u32 v19, v19, v111
    s_mov_b32 s52, 57344
    s_mov_b64 exec, s[62:63]
    s_cbranch_execz K1_ES_20
    buffer_store_dwordx4 v[70:73], v19, s[44:47], s52 offen sc1
K1_ES_20:
    s_mov_b64 exec, -1
    s_waitcnt lgkmcnt(0)
    v_add_u32 v20, v20, v111
    s_mov_b32 s52, 65536
    s_mov_b64 exec, s[64:65]
    s_cbranch_execz K1_ES_21
    buffer_store_dwordx4 v[74:77], v20, s[44:47], s52 offen sc1
K1_ES_21:
    s_mov_b64 exec, -1
K1_CO_18:
K1_ARRIVE_3:
    s_cmp_lg_u32 s3, 4
    s_cbranch_scc1 P2_1
    s_mov_b32 s28, s22
    s_mov_b32 s29, s23
    s_mov_b32 s30, 256
    s_mov_b32 s31, 0x20000
    v_mov_b32 v1, 0
    s_mov_b64 exec, 1
    buffer_load_dwordx2 v[12:13], v1, s[28:31], 0 offen sc1
    s_mov_b64 exec, -1
    s_branch P2_1
K1_AGG_22:
    s_cmp_lg_u32 s3, 4
    s_cbranch_scc1 P2_1
    s_mov_b32 s28, s22
    s_mov_b32 s29, s23
    s_mov_b32 s30, 256
    s_mov_b32 s31, 0x20000
    s_add_u32 s32, s24, 25741952
    s_addc_u32 s33, s25, 0
    s_mov_b32 s34, 128
    s_mov_b32 s35, 0x20000
    v_mov_b32 v1, 0
    s_mov_b64 exec, 1
    buffer_load_dword v2, v1, s[32:35], 0 offen sc1
    s_waitcnt vmcnt(0)
    v_add_u32 v2, 0x09e3779b, v2
    buffer_store_dword v2, v1, s[32:35], 0 offen sc1
    v_and_b32 v3, 0x1fff, v2
    v_bfe_u32 v4, v2, 13, 13
    v_lshl_or_b32 v3, v3, 1, 1
    v_lshl_or_b32 v4, v4, 1, 1
    v_lshlrev_b32 v3, 18, v3
    v_lshlrev_b32 v4, 18, v4
    s_waitcnt vmcnt(0)
    buffer_atomic_add v3, v1, s[28:31], 0 offen
    buffer_atomic_add v4, v1, s[28:31], 0 offen offset:4
    v_mov_b32 v12, v3
    v_mov_b32 v13, v4
    s_mov_b64 exec, -1
    s_branch P2_1
K1_BOP_23:
    s_waitcnt lgkmcnt(0)
    s_cmp_lg_u32 s2, 44
    s_cbranch_scc1 K1_AGG_22
    s_mov_b32 s28, s18
    s_mov_b32 s29, s19
    s_mov_b32 s30, 24576
    s_mov_b32 s31, 0x20000
    s_add_u32 s32, s24, 25683968
    s_addc_u32 s33, s25, 0
    s_mov_b32 s34, 24576
    s_mov_b32 s35, 0x20000
    v_bfe_u32 v1, v0, 4, 1
    v_mul_u32_u24 v1, 12288, v1
    v_and_b32 v2, 15, v0
    v_lshl_add_u32 v1, v2, 2, v1
    s_lshl_b32 s36, s3, 6
    v_add_u32 v1, s36, v1
    v_bfe_u32 v3, v0, 5, 1
    v_xor_b32 v2, 1, v3
    v_lshl_add_u32 v2, v2, 9, v1
    s_movk_i32 s37, 0
    buffer_load_dword v8, v2, s[28:31], s37 offen
    buffer_load_dword v16, v1, s[28:31], s37 offen offset:1024
    s_movk_i32 s37, 1536
    buffer_load_dword v9, v2, s[28:31], s37 offen
    buffer_load_dword v17, v1, s[28:31], s37 offen offset:1024
    s_movk_i32 s37, 3072
    buffer_load_dword v10, v2, s[28:31], s37 offen
    buffer_load_dword v18, v1, s[28:31], s37 offen offset:1024
    s_movk_i32 s37, 4608
    buffer_load_dword v11, v2, s[28:31], s37 offen
    buffer_load_dword v19, v1, s[28:31], s37 offen offset:1024
    s_movk_i32 s37, 6144
    buffer_load_dword v12, v2, s[28:31], s37 offen
    buffer_load_dword v20, v1, s[28:31], s37 offen offset:1024
    s_movk_i32 s37, 7680
    buffer_load_dword v13, v2, s[28:31], s37 offen
    buffer_load_dword v21, v1, s[28:31], s37 offen offset:1024
    s_movk_i32 s37, 9216
    buffer_load_dword v14, v2, s[28:31], s37 offen
    buffer_load_dword v22, v1, s[28:31], s37 offen offset:1024
    s_movk_i32 s37, 10752
    buffer_load_dword v15, v2, s[28:31], s37 offen
    buffer_load_dword v23, v1, s[28:31], s37 offen offset:1024
    s_mov_b32 s38, 0x05040100
    s_mov_b32 s39, 0x07060302
    v_mul_u32_u24 v3, 0x020202, v3
    v_lshl_or_b32 v3, v3, 8, v3
    v_add_u32 v3, s38, v3
    v_and_b32 v4, 63, v0
    v_lshlrev_b32 v4, 4, v4
    s_mul_i32 s36, s3, 3072
    s_waitcnt vmcnt(0)
    v_perm_b32 v24, v9, v8, s39
    v_perm_b32 v28, v9, v8, s38
    v_perm_b32 v32, v17, v16, v3
    v_perm_b32 v25, v11, v10, s39
    v_perm_b32 v29, v11, v10, s38
    v_perm_b32 v33, v19, v18, v3
    v_perm_b32 v26, v13, v12, s39
    v_perm_b32 v30, v13, v12, s38
    v_perm_b32 v34, v21, v20, v3
    v_perm_b32 v27, v15, v14, s39
    v_perm_b32 v31, v15, v14, s38
    v_perm_b32 v35, v23, v22, v3
    buffer_store_dwordx4 v[24:27], v4, s[32:35], s36 offen sc1
    buffer_store_dwordx4 v[28:31], v4, s[32:35], s36 offen offset:1024 sc1
    buffer_store_dwordx4 v[32:35], v4, s[32:35], s36 offen offset:2048 sc1
    s_branch K1_ARRIVE_3
K1_LUT_8:
    s_waitcnt lgkmcnt(0)
    s_mov_b32 s28, s16
    s_mov_b32 s29, s17
    s_mov_b32 s30, 393216
    s_mov_b32 s31, 0x20000
    s_sub_u32 s26, s2, 40
    s_lshl_b32 s26, s26, 16
    v_lshlrev_b32 v1, 7, v0
    buffer_load_dword v254, v1, s[28:31], s26 offen
    s_cmp_ge_u32 s2, 44
    s_cbranch_scc1 K1_BOP_23
    s_waitcnt lgkmcnt(0)
    s_load_dwordx8 s[28:35], s[12:13], 0
    s_add_u32 s60, s24, 25600000
    s_addc_u32 s61, s25, 0
    s_mov_b32 s62, 66560
    s_mov_b32 s63, 0x20000
    s_sub_u32 s56, s2, 40
    s_lshl_b32 s56, s56, 9
    s_add_u32 s56, s56, 32
    v_add_u32 v1, s56, v0
    v_add_u32 v2, 14464, v1
    v_lshlrev_b32 v2, 16, v2
    v_lshlrev_b32 v1, 5, v1
    s_mov_b32 s52, 0x40490fdb
    s_mov_b32 s53, 0x3e4ccccd
    s_mov_b32 s54, 0x3e22f983
    s_waitcnt lgkmcnt(0)
    s_lshl_b32 s36, s28, 16
    s_and_b32 s37, s28, 0xffff0000
    s_lshl_b32 s38, s29, 16
    s_and_b32 s39, s29, 0xffff0000
    s_lshl_b32 s40, s30, 16
    s_and_b32 s41, s30, 0xffff0000
    s_lshl_b32 s42, s31, 16
    s_and_b32 s43, s31, 0xffff0000
    s_lshl_b32 s44, s32, 16
    s_and_b32 s45, s32, 0xffff0000
    s_lshl_b32 s46, s33, 16
    s_and_b32 s47, s33, 0xffff0000
    s_lshl_b32 s48, s34, 16
    s_and_b32 s49, s34, 0xffff0000
    s_lshl_b32 s50, s35, 16
    s_and_b32 s51, s35, 0xffff0000
    v_rcp_f32 v12, v2
    v_mul_f32 v13, s52, v2
    v_cvt_pk_bf16_f32 v13, v13, v13
    v_and_b32 v13, 0xffff0000, v13
    v_mul_f32 v13, s53, v13
    v_cvt_pk_bf16_f32 v13, v13, v13
    v_and_b32 v13, 0xffff0000, v13
    v_mul_f32 v13, s54, v13
    v_cos_f32 v13, v13
    s_nop 0
    v_cvt_pk_bf16_f32 v13, v13, v13
    v_and_b32 v13, 0xffff0000, v13
    v_add_f32 v13, 1.0, v13
    v_cvt_pk_bf16_f32 v13, v13, v13
    v_and_b32 v13, 0xffff0000, v13
    v_mul_f32 v13, 0.5, v13
    v_mul_f32 v14, s36, v2
    v_mul_f32 v15, s37, v2
    v_cvt_pk_bf16_f32 v16, v14, v15
    v_lshlrev_b32 v14, 16, v16
    v_and_b32 v15, 0xffff0000, v16
    v_mul_f32 v14, s54, v14
    v_mul_f32 v15, s54, v15
    v_rndne_f32 v17, v14
    v_rndne_f32 v18, v15
    v_sub_f32 v14, v14, v17
    v_sub_f32 v15, v15, v18
    v_sin_f32 v14, v14
    v_sin_f32 v15, v15
    s_nop 0
    v_cvt_pk_bf16_f32 v16, v14, v15
    v_lshlrev_b32 v14, 16, v16
    v_and_b32 v15, 0xffff0000, v16
    v_mul_f32 v14, v14, v12
    v_mul_f32 v15, v15, v12
    v_cvt_pk_bf16_f32 v16, v14, v15
    v_lshlrev_b32 v14, 16, v16
    v_and_b32 v15, 0xffff0000, v16
    v_mul_f32 v14, v14, v13
    v_mul_f32 v15, v15, v13
    v_cvt_pk_bf16_f32 v4, v14, v15
    v_mul_f32 v14, s38, v2
    v_mul_f32 v15, s39, v2
    v_cvt_pk_bf16_f32 v16, v14, v15
    v_lshlrev_b32 v14, 16, v16
    v_and_b32 v15, 0xffff0000, v16
    v_mul_f32 v14, s54, v14
    v_mul_f32 v15, s54, v15
    v_rndne_f32 v17, v14
    v_rndne_f32 v18, v15
    v_sub_f32 v14, v14, v17
    v_sub_f32 v15, v15, v18
    v_sin_f32 v14, v14
    v_sin_f32 v15, v15
    s_nop 0
    v_cvt_pk_bf16_f32 v16, v14, v15
    v_lshlrev_b32 v14, 16, v16
    v_and_b32 v15, 0xffff0000, v16
    v_mul_f32 v14, v14, v12
    v_mul_f32 v15, v15, v12
    v_cvt_pk_bf16_f32 v16, v14, v15
    v_lshlrev_b32 v14, 16, v16
    v_and_b32 v15, 0xffff0000, v16
    v_mul_f32 v14, v14, v13
    v_mul_f32 v15, v15, v13
    v_cvt_pk_bf16_f32 v5, v14, v15
    v_mul_f32 v14, s40, v2
    v_mul_f32 v15, s41, v2
    v_cvt_pk_bf16_f32 v16, v14, v15
    v_lshlrev_b32 v14, 16, v16
    v_and_b32 v15, 0xffff0000, v16
    v_mul_f32 v14, s54, v14
    v_mul_f32 v15, s54, v15
    v_rndne_f32 v17, v14
    v_rndne_f32 v18, v15
    v_sub_f32 v14, v14, v17
    v_sub_f32 v15, v15, v18
    v_sin_f32 v14, v14
    v_sin_f32 v15, v15
    s_nop 0
    v_cvt_pk_bf16_f32 v16, v14, v15
    v_lshlrev_b32 v14, 16, v16
    v_and_b32 v15, 0xffff0000, v16
    v_mul_f32 v14, v14, v12
    v_mul_f32 v15, v15, v12
    v_cvt_pk_bf16_f32 v16, v14, v15
    v_lshlrev_b32 v14, 16, v16
    v_and_b32 v15, 0xffff0000, v16
    v_mul_f32 v14, v14, v13
    v_mul_f32 v15, v15, v13
    v_cvt_pk_bf16_f32 v6, v14, v15
    v_mul_f32 v14, s42, v2
    v_mul_f32 v15, s43, v2
    v_cvt_pk_bf16_f32 v16, v14, v15
    v_lshlrev_b32 v14, 16, v16
    v_and_b32 v15, 0xffff0000, v16
    v_mul_f32 v14, s54, v14
    v_mul_f32 v15, s54, v15
    v_rndne_f32 v17, v14
    v_rndne_f32 v18, v15
    v_sub_f32 v14, v14, v17
    v_sub_f32 v15, v15, v18
    v_sin_f32 v14, v14
    v_sin_f32 v15, v15
    s_nop 0
    v_cvt_pk_bf16_f32 v16, v14, v15
    v_lshlrev_b32 v14, 16, v16
    v_and_b32 v15, 0xffff0000, v16
    v_mul_f32 v14, v14, v12
    v_mul_f32 v15, v15, v12
    v_cvt_pk_bf16_f32 v16, v14, v15
    v_lshlrev_b32 v14, 16, v16
    v_and_b32 v15, 0xffff0000, v16
    v_mul_f32 v14, v14, v13
    v_mul_f32 v15, v15, v13
    v_cvt_pk_bf16_f32 v7, v14, v15
    v_mul_f32 v14, s44, v2
    v_mul_f32 v15, s45, v2
    v_cvt_pk_bf16_f32 v16, v14, v15
    v_lshlrev_b32 v14, 16, v16
    v_and_b32 v15, 0xffff0000, v16
    v_mul_f32 v14, s54, v14
    v_mul_f32 v15, s54, v15
    v_rndne_f32 v17, v14
    v_rndne_f32 v18, v15
    v_sub_f32 v14, v14, v17
    v_sub_f32 v15, v15, v18
    v_sin_f32 v14, v14
    v_sin_f32 v15, v15
    s_nop 0
    v_cvt_pk_bf16_f32 v16, v14, v15
    v_lshlrev_b32 v14, 16, v16
    v_and_b32 v15, 0xffff0000, v16
    v_mul_f32 v14, v14, v12
    v_mul_f32 v15, v15, v12
    v_cvt_pk_bf16_f32 v16, v14, v15
    v_lshlrev_b32 v14, 16, v16
    v_and_b32 v15, 0xffff0000, v16
    v_mul_f32 v14, v14, v13
    v_mul_f32 v15, v15, v13
    v_cvt_pk_bf16_f32 v8, v14, v15
    v_mul_f32 v14, s46, v2
    v_mul_f32 v15, s47, v2
    v_cvt_pk_bf16_f32 v16, v14, v15
    v_lshlrev_b32 v14, 16, v16
    v_and_b32 v15, 0xffff0000, v16
    v_mul_f32 v14, s54, v14
    v_mul_f32 v15, s54, v15
    v_rndne_f32 v17, v14
    v_rndne_f32 v18, v15
    v_sub_f32 v14, v14, v17
    v_sub_f32 v15, v15, v18
    v_sin_f32 v14, v14
    v_sin_f32 v15, v15
    s_nop 0
    v_cvt_pk_bf16_f32 v16, v14, v15
    v_lshlrev_b32 v14, 16, v16
    v_and_b32 v15, 0xffff0000, v16
    v_mul_f32 v14, v14, v12
    v_mul_f32 v15, v15, v12
    v_cvt_pk_bf16_f32 v16, v14, v15
    v_lshlrev_b32 v14, 16, v16
    v_and_b32 v15, 0xffff0000, v16
    v_mul_f32 v14, v14, v13
    v_mul_f32 v15, v15, v13
    v_cvt_pk_bf16_f32 v9, v14, v15
    v_mul_f32 v14, s48, v2
    v_mul_f32 v15, s49, v2
    v_cvt_pk_bf16_f32 v16, v14, v15
    v_lshlrev_b32 v14, 16, v16
    v_and_b32 v15, 0xffff0000, v16
    v_mul_f32 v14, s54, v14
    v_mul_f32 v15, s54, v15
    v_rndne_f32 v17, v14
    v_rndne_f32 v18, v15
    v_sub_f32 v14, v14, v17
    v_sub_f32 v15, v15, v18
    v_sin_f32 v14, v14
    v_sin_f32 v15, v15
    s_nop 0
    v_cvt_pk_bf16_f32 v16, v14, v15
    v_lshlrev_b32 v14, 16, v16
    v_and_b32 v15, 0xffff0000, v16
    v_mul_f32 v14, v14, v12
    v_mul_f32 v15, v15, v12
    v_cvt_pk_bf16_f32 v16, v14, v15
    v_lshlrev_b32 v14, 16, v16
    v_and_b32 v15, 0xffff0000, v16
    v_mul_f32 v14, v14, v13
    v_mul_f32 v15, v15, v13
    v_cvt_pk_bf16_f32 v10, v14, v15
    v_mul_f32 v14, s50, v2
    v_mul_f32 v15, s51, v2
    v_cvt_pk_bf16_f32 v16, v14, v15
    v_lshlrev_b32 v14, 16, v16
    v_and_b32 v15, 0xffff0000, v16
    v_mul_f32 v14, s54, v14
    v_mul_f32 v15, s54, v15
    v_rndne_f32 v17, v14
    v_rndne_f32 v18, v15
    v_sub_f32 v14, v14, v17
    v_sub_f32 v15, v15, v18
    v_sin_f32 v14, v14
    v_sin_f32 v15, v15
    s_nop 0
    v_cvt_pk_bf16_f32 v16, v14, v15
    v_lshlrev_b32 v14, 16, v16
    v_and_b32 v15, 0xffff0000, v16
    v_mul_f32 v14, v14, v12
    v_mul_f32 v15, v15, v12
    v_cvt_pk_bf16_f32 v16, v14, v15
    v_lshlrev_b32 v14, 16, v16
    v_and_b32 v15, 0xffff0000, v16
    v_mul_f32 v14, v14, v13
    v_mul_f32 v15, v15, v13
    v_cvt_pk_bf16_f32 v11, v14, v15
    buffer_store_dwordx4 v[4:7], v1, s[60:63], 0 offen sc1
    buffer_store_dwordx4 v[8:11], v1, s[60:63], 0 offen offset:16 sc1
    s_branch K1_ARRIVE_3
CODE_END_4:
.section .rodata,"a"
.p2align 6
.amdhsa_kernel standalone__molecular_angular_painn__graph_kernel
  .amdhsa_next_free_vgpr 256
  .amdhsa_next_free_sgpr 102
  .amdhsa_accum_offset 256
  .amdhsa_group_segment_fixed_size 0
  .amdhsa_kernarg_size 88
  .amdhsa_user_sgpr_count 2
  .amdhsa_user_sgpr_kernarg_segment_ptr 1
  .amdhsa_system_sgpr_workgroup_id_x 1
.end_amdhsa_kernel
```
